```python
import torch

def _softmax(x, axis=-1):
    return torch.softmax(x, dim=axis)
def _gelu(x):
    return torch.nn.functional.gelu(x, approximate="tanh")
def _silu(x):
    return torch.nn.functional.silu(x)
def _sigmoid(x):
    return torch.sigmoid(x)
def _layernorm(x, axis=-1, eps=1e-5):
    m = x.mean(dim=axis, keepdim=True)
    v = x.var(dim=axis, keepdim=True, unbiased=False)
    return (x - m) / torch.sqrt(v + eps)
def _scatter_add(tgt, idx, src, axis=0):
    return tgt.clone().index_add_(axis, idx, src)
def _segment_sum(src, seg, n):
    out = torch.zeros((n,) + src.shape[1:], dtype=src.dtype)
    return out.index_add_(0, seg, src)
def _pad(x, pw):
    flat = tuple(v for pair in reversed(pw) for v in pair)
    return torch.nn.functional.pad(x, flat)

kernel_name = 'parallel_sum__mha_block_cached__glu_gated_reglu__decode'

def setup_inputs():

    _w = (lambda a: (lambda t: t.to(torch.bfloat16) if t.is_floating_point() else t)(torch.as_tensor(a)))
    def _A_setup():
        B, Sq, D = 1, 1, 640
        H, Sk, Dh = 32, 32768, 192
        return {
            "x": _w((lambda *s: torch.randn(*s, dtype=torch.bfloat16) * 0.05)(B, Sq, D)),
            "k_cache": _w((lambda *s: torch.randn(*s, dtype=torch.bfloat16) * 3.2)(B, H, Sk, Dh)),
            "v_cache": _w((lambda *s: torch.randn(*s, dtype=torch.bfloat16) * 1.6)(B, H, Sk, Dh)),
            "wq": _w((lambda *s: torch.randn(*s, dtype=torch.bfloat16) * 3.2)(D, H * Dh) * (D ** -0.5)),
            "wo": _w((lambda *s: torch.randn(*s, dtype=torch.bfloat16) * 1.6)(H * Dh, D) * ((H * Dh) ** -0.5)),
        }
    _A_in = _A_setup()

    def _B_setup():
        B, S, D, F = 1, 1, 640, 1536
        return {
            "x": _w((lambda *s: torch.randn(*s, dtype=torch.bfloat16) * 0.05)(B, S, D)),
            "W_gate": _w((lambda *s: torch.randn(*s, dtype=torch.bfloat16) * 1.6)(D, F) * (2.0 / D) ** 0.5),
            "W_up": _w((lambda *s: torch.randn(*s, dtype=torch.bfloat16) * 1.6)(D, F) * (2.0 / D) ** 0.5),
            "W_down": _w((lambda *s: torch.randn(*s, dtype=torch.bfloat16) * 1.6)(F, D) * (1.0 / F) ** 0.5),
        }
    _B_in = _B_setup()

    return {
        "A_x": _A_in["x"],
        "A_k_cache": _A_in["k_cache"],
        "A_v_cache": _A_in["v_cache"],
        "A_wq": _A_in["wq"],
        "A_wo": _A_in["wo"],
        "B_x": _B_in["x"],
        "B_W_gate": _B_in["W_gate"],
        "B_W_up": _B_in["W_up"],
        "B_W_down": _B_in["W_down"],
    }

def reference(A_x, A_k_cache, A_v_cache, A_wq, A_wo, B_x, B_W_gate, B_W_up, B_W_down):
    def _A_ref(x, k_cache, v_cache, wq, wo):
        B, Sq, D = x.shape
        H, Dh = 32, 192
        q = (lambda x, *d: x.permute(*d))((x @ wq).reshape(B, Sq, H, Dh), 0, 2, 1, 3)
        scores = torch.einsum("bhqd,bhkd->bhqk", q, k_cache) * (Dh ** -0.5)
        p = _softmax(scores, axis=-1)
        o = torch.einsum("bhqk,bhkd->bhqd", p, v_cache)
        return (lambda x, *d: x.permute(*d))(o, 0, 2, 1, 3).reshape(B, Sq, H * Dh) @ wo

    def _B_ref(x, W_gate, W_up, W_down):
        gate = torch.einsum("bsd,df->bsf", x, W_gate)
        up = torch.einsum("bsd,df->bsf", x, W_up)
        gate = gate * (lambda x, dt: x.to(dt))(gate > 0, gate.dtype)
        h = gate * up
        return torch.einsum("bsf,fd->bsd", h, W_down)

    x = A_x
    xn = _layernorm(x, axis=-1)
    return x + _A_ref(xn, A_k_cache, A_v_cache, A_wq, A_wo) + _B_ref(xn, B_W_gate, B_W_up, B_W_down)
```

```asm
; @launch grid=(256,1,1) block=(320,1,1) lds=63232
.amdgcn_target "amdgcn-amd-amdhsa--gfx950"
.text
.globl parallel_sum__mha_block_cached__glu_gated_reglu__decode_kernel
.p2align 8
.type parallel_sum__mha_block_cached__glu_gated_reglu__decode_kernel,@function
parallel_sum__mha_block_cached__glu_gated_reglu__decode_kernel:
    s_load_dwordx16 s[36:51], s[0:1], 0
    s_load_dwordx8 s[52:59], s[0:1], 64
    s_cmp_ge_u32 s2, 256
    s_cbranch_scc1 L_end
    s_setprio 3
    v_bfe_u32 v2, v0, 3, 3
    v_lshrrev_b32 v1, 6, v0
    v_and_b32 v3, 7, v0
    v_lshl_add_u32 v6, v1, 4, v2
    v_lshlrev_b32 v9, 4, v3
    v_mul_u32_u24 v4, 12288, v6
    v_mov_b32 v8, 0
    v_add_u32 v4, v4, v9
    ds_write_b32 v8, v8 offset:46528
    s_and_b32 s65, s2, 7
    s_lshr_b32 s66, s2, 3
    s_lshl_b32 s67, s65, 5
    s_add_u32 s64, s67, s66
    s_lshr_b32 s6, s65, 1
    s_and_b32 s5, s66, 7
    s_lshr_b32 s67, s64, 1
    s_and_b32 s67, s67, 28
    s_add_u32 s4, s67, s6
    s_mul_i32 s68, s5, 983040
    s_mul_i32 s69, s4, 384
    s_add_u32 s68, s68, s69
    s_mov_b32 s22, 7864320
    s_mov_b32 s23, 0x20000
    s_waitcnt lgkmcnt(0)
    s_mov_b64 s[20:21], s[42:43]
    buffer_load_dwordx4 v[56:59], v4, s[20:23], s68 offen offset:0 nt
    buffer_load_dwordx4 v[60:63], v4, s[20:23], s68 offen offset:128 nt
    buffer_load_dwordx4 v[64:67], v4, s[20:23], s68 offen offset:256 nt
    s_add_u32 s68, s68, 98304
    v_and_b32 v0, 63, v0
    v_mul_u32_u24 v5, 3072, v6
    v_lshlrev_b32 v6, 1, v6
    v_lshlrev_b32 v7, 4, v0
    s_mul_i32 s67, s5, 160
    s_mov_b32 s34, 1280
    s_mov_b32 s35, 0x20000
    s_mov_b64 s[32:33], s[36:37]
    buffer_load_dwordx4 v[96:99], v7, s[32:35], 0 offen
    buffer_load_dwordx4 v[100:103], v7, s[32:35], 0 offen offset:1024
    buffer_load_ushort v54, v6, s[32:35], s67 offen
    buffer_load_ushort v55, v6, s[32:35], s67 offen offset:16
    v_readfirstlane_b32 s3, v1
    v_add_u32 v5, v5, v9
    v_mov_b32 v10, 1073741824
    v_cmp_gt_u32 vcc, 6, v3
    v_mul_u32_u24 v1, 384, v2
    v_add_u32 v1, v1, v9
    v_cndmask_b32 v5, v10, v5, vcc
    s_mul_i32 s69, s5, 245760
    s_lshr_b32 s70, s64, 3
    s_mul_i32 s70, s70, 96
    s_add_u32 s69, s69, s70
    s_mov_b32 s26, 1966080
    s_mov_b32 s27, 0x20000
    s_mov_b32 s30, 1966080
    s_mov_b32 s31, 0x20000
    s_mov_b64 s[24:25], s[48:49]
    s_mov_b64 s[28:29], s[50:51]
    s_load_dword s46, s[58:59], 0
    s_barrier
    buffer_load_dwordx4 v[76:79], v4, s[20:23], s68 offen offset:0 nt
    buffer_load_dwordx4 v[80:83], v4, s[20:23], s68 offen offset:128 nt
    buffer_load_dwordx4 v[84:87], v4, s[20:23], s68 offen offset:256 nt
    buffer_load_dwordx4 v[68:71], v5, s[24:27], s69 offen nt
    buffer_load_dwordx4 v[72:75], v5, s[28:31], s69 offen nt
    s_add_u32 s69, s69, 24576
    buffer_load_dwordx4 v[88:91], v5, s[24:27], s69 offen nt
    buffer_load_dwordx4 v[92:95], v5, s[28:31], s69 offen nt
    s_mov_b64 s[8:9], s[38:39]
    s_mov_b32 s10, 402653184
    s_mov_b32 s11, 0x20000
    s_mov_b64 s[16:17], s[58:59]
    s_mov_b32 s18, 4194304
    s_mov_b32 s19, 0x20000
    s_and_b32 s7, s64, 63
    s_sub_u32 s3, s3, 1
    s_cselect_b32 s3, 4, s3
    s_lshl_b32 s67, s7, 2
    s_add_u32 s67, s67, s3
    s_mul_i32 s67, s67, 3072
    s_mul_i32 s61, s6, 12582912
    s_add_u32 s61, s61, s67
    s_mov_b32 s60, s61
    s_mov_b32 s12, 0xcccccccc
    s_mov_b32 s13, 0xcccccccc
    s_mov_b32 s14, 0xaaaaaaaa
    s_mov_b32 s15, 0xaaaaaaaa
    s_and_b32 s71, s65, 1
    s_xor_b32 s71, s71, 1
    s_cmp_lg_u32 s3, 4
    s_cbranch_scc1 L_not
    s_getpc_b64 s[74:75]
L_pc1:
    s_lshl_b32 s76, s66, 10
    v_add_u32 v192, s76, v7
    v_min_u32 v192, L_end-parallel_sum__mha_block_cached__glu_gated_reglu__decode_kernel-16, v192
    s_sub_u32 s74, s74, L_pc1-parallel_sum__mha_block_cached__glu_gated_reglu__decode_kernel
    s_subb_u32 s75, s75, 0
    v_mov_b32 v193, s75
    v_add_co_u32 v192, vcc, s74, v192
    s_nop 1
    v_addc_co_u32 v193, vcc, 0, v193, vcc
    global_load_dword v194, v[192:193], off
    s_lshl_b32 s67, s64, 11
    s_add_u32 s67, s67, 1048576
    buffer_load_dword v196, v7, s[16:19], s67 offen offset:0 sc1
    buffer_load_dword v196, v7, s[16:19], s67 offen offset:1024 sc1
    s_lshl_b32 s67, s64, 11
    s_add_u32 s67, s67, 525312
    buffer_load_dword v196, v7, s[16:19], s67 offen offset:0 sc1
L_not:
    s_mov_b64 s[20:21], s[44:45]
    s_mov_b32 s22, 7864320
    s_mov_b32 s23, 0x20000
    s_mov_b64 s[24:25], s[52:53]
    s_mov_b32 s26, 1966080
    s_mov_b32 s27, 0x20000
    s_lshl_b32 s69, s5, 3
    s_lshr_b32 s68, s66, 3
    s_lshl_b32 s68, s68, 1
    s_add_u32 s69, s69, s68
    s_mul_i32 s68, s6, 192
    s_add_u32 s69, s69, s68
    s_lshl_b32 s67, s3, 1
    s_add_u32 s67, s67, s71
    s_lshl_b32 s67, s67, 2
    s_lshr_b32 s67, 0x1234576, s67
    s_and_b32 s67, s67, 7
    s_mul_i32 s67, s67, 768
    s_add_u32 s67, s67, s69
    s_mul_i32 s80, s67, 1280
    s_add_u32 s81, s80, 81920
    s_add_u32 s82, s80, 163840
    s_lshl_b32 s67, s3, 6
    s_add_u32 s67, s67, s69
    s_add_u32 s67, s67, 0
    s_mul_i32 s76, s67, 1280
    s_mul_i32 s77, s3, 2560
    s_mul_i32 s67, s64, 7680
    s_lshl_b32 s79, s3, 11
    s_add_u32 s78, s67, s79
    s_cmp_eq_u32 s3, 4
    s_cbranch_scc1 L_ln
    s_setprio 1
    s_waitcnt vmcnt(7)
    s_branch L_ln2
L_ln:
    s_waitcnt vmcnt(11)
L_ln2:
    s_waitcnt lgkmcnt(0)
    s_mul_i32 s46, s46, 1664525
    s_add_u32 s46, s46, 1013904223
    v_lshlrev_b32 v8, 16, v96
    v_and_b32 v9, 0xffff0000, v96
    v_lshlrev_b32 v10, 16, v97
    v_and_b32 v11, 0xffff0000, v97
    v_lshlrev_b32 v12, 16, v98
    v_and_b32 v13, 0xffff0000, v98
    v_lshlrev_b32 v14, 16, v99
    v_and_b32 v15, 0xffff0000, v99
    v_lshlrev_b32 v16, 16, v100
    v_and_b32 v17, 0xffff0000, v100
    v_lshlrev_b32 v18, 16, v101
    v_and_b32 v19, 0xffff0000, v101
    v_lshlrev_b32 v20, 16, v102
    v_and_b32 v21, 0xffff0000, v102
    v_lshlrev_b32 v22, 16, v103
    v_and_b32 v23, 0xffff0000, v103
    v_add_f32 v24, v8, v9
    v_add_f32 v25, v10, v11
    v_add_f32 v24, v24, v12
    v_add_f32 v25, v25, v13
    v_add_f32 v24, v24, v14
    v_add_f32 v25, v25, v15
    v_add_f32 v24, v24, v16
    v_add_f32 v25, v25, v17
    v_add_f32 v24, v24, v18
    v_add_f32 v25, v25, v19
    v_add_f32 v24, v24, v20
    v_add_f32 v25, v25, v21
    v_add_f32 v24, v24, v22
    v_add_f32 v25, v25, v23
    v_add_f32 v24, v24, v25
    s_nop 1
    v_add_f32_dpp v24, v24, v24 quad_perm:[1,0,3,2] row_mask:0xf bank_mask:0xf
    s_nop 1
    v_add_f32_dpp v24, v24, v24 quad_perm:[2,3,0,1] row_mask:0xf bank_mask:0xf
    s_nop 1
    v_add_f32_dpp v24, v24, v24 row_half_mirror row_mask:0xf bank_mask:0xf
    s_nop 1
    v_add_f32_dpp v24, v24, v24 row_mirror row_mask:0xf bank_mask:0xf
    v_mov_b32 v25, v24
    s_nop 1
    v_permlane16_swap_b32 v25, v24
    v_add_f32 v24, v24, v25
    v_mov_b32 v25, v24
    s_nop 1
    v_permlane32_swap_b32 v25, v24
    v_add_f32 v24, v24, v25
    v_mul_f32 v24, 0x3acccccd, v24
    v_sub_f32 v8, v8, v24
    v_sub_f32 v9, v9, v24
    v_sub_f32 v10, v10, v24
    v_sub_f32 v11, v11, v24
    v_sub_f32 v12, v12, v24
    v_sub_f32 v13, v13, v24
    v_sub_f32 v14, v14, v24
    v_sub_f32 v15, v15, v24
    v_sub_f32 v16, v16, v24
    v_sub_f32 v17, v17, v24
    v_sub_f32 v18, v18, v24
    v_sub_f32 v19, v19, v24
    v_sub_f32 v20, v20, v24
    v_sub_f32 v21, v21, v24
    v_sub_f32 v22, v22, v24
    v_sub_f32 v23, v23, v24
    v_mul_f32 v25, v8, v8
    v_mul_f32 v26, v16, v16
    v_fmac_f32 v25, v9, v9
    v_fmac_f32 v26, v17, v17
    v_fmac_f32 v25, v10, v10
    v_fmac_f32 v26, v18, v18
    v_fmac_f32 v25, v11, v11
    v_fmac_f32 v26, v19, v19
    v_fmac_f32 v25, v12, v12
    v_fmac_f32 v26, v20, v20
    v_fmac_f32 v25, v13, v13
    v_fmac_f32 v26, v21, v21
    v_fmac_f32 v25, v14, v14
    v_fmac_f32 v26, v22, v22
    v_fmac_f32 v25, v15, v15
    v_fmac_f32 v26, v23, v23
    v_cmp_gt_u32 vcc, 16, v0
    s_nop 1
    v_cndmask_b32 v26, 0, v26, vcc
    v_add_f32 v25, v25, v26
    s_nop 1
    v_add_f32_dpp v25, v25, v25 quad_perm:[1,0,3,2] row_mask:0xf bank_mask:0xf
    s_nop 1
    v_add_f32_dpp v25, v25, v25 quad_perm:[2,3,0,1] row_mask:0xf bank_mask:0xf
    s_nop 1
    v_add_f32_dpp v25, v25, v25 row_half_mirror row_mask:0xf bank_mask:0xf
    s_nop 1
    v_add_f32_dpp v25, v25, v25 row_mirror row_mask:0xf bank_mask:0xf
    v_mov_b32 v26, v25
    s_nop 1
    v_permlane16_swap_b32 v26, v25
    v_add_f32 v25, v25, v26
    v_mov_b32 v26, v25
    s_nop 1
    v_permlane32_swap_b32 v26, v25
    v_add_f32 v25, v25, v26
    v_mul_f32 v25, 0x3acccccd, v25
    v_readfirstlane_b32 s67, v24
    v_readfirstlane_b32 s68, v25
    s_mul_i32 s67, s67, 0x9E3779B1
    s_add_u32 s67, s67, s68
    s_lshl_b32 s67, s67, 2
    s_add_u32 s46, s46, s67
    v_cvt_pk_bf16_f32 v24, 0, v24
    v_cvt_pk_bf16_f32 v25, 0, v25
    v_add_f32 v25, 0x3727c5ac, v25
    v_cvt_pk_bf16_f32 v25, 0, v25
    v_sqrt_f32 v25, v25
    s_nop 0
    v_cvt_pk_bf16_f32 v25, 0, v25
    v_rcp_f32 v26, v25
    v_lshlrev_b32 v54, 16, v54
    v_sub_f32 v54, v54, v24
    v_cvt_pk_bf16_f32 v54, 0, v54
    v_mul_f32 v27, v54, v26
    v_fma_f32 v54, -v27, v25, v54
    v_fma_f32 v54, v54, v26, v27
    v_cvt_pk_bf16_f32 v50, v54, 0
    v_cvt_pk_bf16_f32 v51, 0, v54
    v_lshlrev_b32 v55, 16, v55
    v_sub_f32 v55, v55, v24
    v_cvt_pk_bf16_f32 v55, 0, v55
    v_mul_f32 v27, v55, v26
    v_fma_f32 v55, -v27, v25, v55
    v_fma_f32 v55, v55, v26, v27
    v_cvt_pk_bf16_f32 v52, v55, 0
    v_cvt_pk_bf16_f32 v53, 0, v55
    v_mov_b32 v8, 0
    v_mov_b32 v9, 0
    v_mov_b32 v10, 0
    v_mov_b32 v11, 0
    v_mov_b32 v12, 0
    v_mov_b32 v13, 0
    v_mov_b32 v14, 0
    v_mov_b32 v15, 0
    v_mov_b32 v16, 0
    v_mov_b32 v17, 0
    v_mov_b32 v18, 0
    v_mov_b32 v19, 0
    v_mov_b32 v20, 0
    v_mov_b32 v21, 0
    v_mov_b32 v22, 0
    v_mov_b32 v23, 0
    v_mov_b32 v24, 0
    v_mov_b32 v25, 0
    v_mov_b32 v26, 0
    v_mov_b32 v27, 0
    v_mov_b32 v28, 0
    v_mov_b32 v29, 0
    v_mov_b32 v30, 0
    v_mov_b32 v31, 0
    v_mov_b32 v32, 0
    v_mov_b32 v33, 0
    v_mov_b32 v34, 0
    v_mov_b32 v35, 0
    v_mov_b32 v36, 0
    v_mov_b32 v37, 0
    v_mov_b32 v38, 0
    v_mov_b32 v39, 0
    v_mov_b32 v40, 0
    v_mov_b32 v41, 0
    v_mov_b32 v42, 0
    v_mov_b32 v43, 0
    v_mov_b32 v44, 0
    v_mov_b32 v45, 0
    v_mov_b32 v46, 0
    v_mov_b32 v47, 0
    s_cmp_eq_u32 s3, 4
    s_cbranch_scc1 L_nopre0
    s_waitcnt vmcnt(4)
    s_add_u32 m0, s79, 8192
    s_nop 0
    buffer_load_dwordx4 v7, s[24:27], s78 offen offset:0 nt lds
    s_cmp_eq_u32 s3, 3
    s_cselect_b32 exec_hi, 0, -1
    buffer_load_dwordx4 v7, s[24:27], s78 offen offset:1024 nt lds
    s_mov_b32 exec_hi, -1
    s_branch L_pre1
L_nopre0:
    s_waitcnt vmcnt(8)
L_pre1:
    v_dot2c_f32_bf16 v8, v56, v50
    v_dot2c_f32_bf16 v9, v56, v51
    v_dot2c_f32_bf16 v10, v57, v50
    v_dot2c_f32_bf16 v11, v57, v51
    v_dot2c_f32_bf16 v12, v58, v50
    v_dot2c_f32_bf16 v13, v58, v51
    v_dot2c_f32_bf16 v14, v59, v50
    v_dot2c_f32_bf16 v15, v59, v51
    v_dot2c_f32_bf16 v16, v60, v50
    v_dot2c_f32_bf16 v17, v60, v51
    v_dot2c_f32_bf16 v18, v61, v50
    v_dot2c_f32_bf16 v19, v61, v51
    v_dot2c_f32_bf16 v20, v62, v50
    v_dot2c_f32_bf16 v21, v62, v51
    v_dot2c_f32_bf16 v22, v63, v50
    v_dot2c_f32_bf16 v23, v63, v51
    v_dot2c_f32_bf16 v24, v64, v50
    v_dot2c_f32_bf16 v25, v64, v51
    v_dot2c_f32_bf16 v26, v65, v50
    v_dot2c_f32_bf16 v27, v65, v51
    v_dot2c_f32_bf16 v28, v66, v50
    v_dot2c_f32_bf16 v29, v66, v51
    v_dot2c_f32_bf16 v30, v67, v50
    v_dot2c_f32_bf16 v31, v67, v51
    v_dot2c_f32_bf16 v8, v76, v52
    v_dot2c_f32_bf16 v9, v76, v53
    v_dot2c_f32_bf16 v10, v77, v52
    v_dot2c_f32_bf16 v11, v77, v53
    v_dot2c_f32_bf16 v12, v78, v52
    v_dot2c_f32_bf16 v13, v78, v53
    v_dot2c_f32_bf16 v14, v79, v52
    v_dot2c_f32_bf16 v15, v79, v53
    v_dot2c_f32_bf16 v16, v80, v52
    v_dot2c_f32_bf16 v17, v80, v53
    v_dot2c_f32_bf16 v18, v81, v52
    v_dot2c_f32_bf16 v19, v81, v53
    v_dot2c_f32_bf16 v20, v82, v52
    v_dot2c_f32_bf16 v21, v82, v53
    v_dot2c_f32_bf16 v22, v83, v52
    v_dot2c_f32_bf16 v23, v83, v53
    v_dot2c_f32_bf16 v24, v84, v52
    v_dot2c_f32_bf16 v25, v84, v53
    v_dot2c_f32_bf16 v26, v85, v52
    v_dot2c_f32_bf16 v27, v85, v53
    v_dot2c_f32_bf16 v28, v86, v52
    v_dot2c_f32_bf16 v29, v86, v53
    v_dot2c_f32_bf16 v30, v87, v52
    v_dot2c_f32_bf16 v31, v87, v53
    s_cmp_eq_u32 s3, 4
    s_cbranch_scc1 L_nopre1
    s_waitcnt vmcnt(2)
    s_cmp_eq_u32 s3, 3
    s_cbranch_scc1 L_nos4
    s_add_u32 m0, s77, 15872
    s_nop 0
    buffer_load_dwordx4 v7, s[20:23], s76 offen offset:0 nt lds
    buffer_load_dwordx4 v7, s[20:23], s76 offen offset:1024 nt lds
    s_mov_b32 exec_hi, 0
    buffer_load_dwordx4 v7, s[20:23], s76 offen offset:2048 nt lds
    s_mov_b32 exec_hi, -1
    s_add_u32 s76, s76, 81920
L_nos4:
    buffer_load_dwordx4 v[104:107], v1, s[8:11], s60 offen offset:0 nt
    s_branch L_pre2
L_nopre1:
    s_waitcnt vmcnt(4)
L_pre2:
    v_dot2c_f32_bf16 v32, v68, v50
    v_dot2c_f32_bf16 v33, v68, v51
    v_dot2c_f32_bf16 v34, v69, v50
    v_dot2c_f32_bf16 v35, v69, v51
    v_dot2c_f32_bf16 v36, v70, v50
    v_dot2c_f32_bf16 v37, v70, v51
    v_dot2c_f32_bf16 v38, v71, v50
    v_dot2c_f32_bf16 v39, v71, v51
    v_dot2c_f32_bf16 v40, v72, v50
    v_dot2c_f32_bf16 v41, v72, v51
    v_dot2c_f32_bf16 v42, v73, v50
    v_dot2c_f32_bf16 v43, v73, v51
    v_dot2c_f32_bf16 v44, v74, v50
    v_dot2c_f32_bf16 v45, v74, v51
    v_dot2c_f32_bf16 v46, v75, v50
    v_dot2c_f32_bf16 v47, v75, v51
    v_dot2c_f32_bf16 v32, v88, v52
    v_dot2c_f32_bf16 v33, v88, v53
    v_dot2c_f32_bf16 v34, v89, v52
    v_dot2c_f32_bf16 v35, v89, v53
    v_dot2c_f32_bf16 v36, v90, v52
    v_dot2c_f32_bf16 v37, v90, v53
    v_dot2c_f32_bf16 v38, v91, v52
    v_dot2c_f32_bf16 v39, v91, v53
    v_dot2c_f32_bf16 v40, v92, v52
    v_dot2c_f32_bf16 v41, v92, v53
    v_dot2c_f32_bf16 v42, v93, v52
    v_dot2c_f32_bf16 v43, v93, v53
    v_dot2c_f32_bf16 v44, v94, v52
    v_dot2c_f32_bf16 v45, v94, v53
    v_dot2c_f32_bf16 v46, v95, v52
    v_dot2c_f32_bf16 v47, v95, v53
    v_permlane32_swap_b32 v8, v12
    v_permlane32_swap_b32 v9, v13
    v_permlane32_swap_b32 v10, v14
    v_permlane32_swap_b32 v11, v15
    v_permlane32_swap_b32 v16, v20
    v_permlane32_swap_b32 v17, v21
    v_permlane32_swap_b32 v18, v22
    v_permlane32_swap_b32 v19, v23
    v_permlane32_swap_b32 v24, v28
    v_permlane32_swap_b32 v25, v29
    v_permlane32_swap_b32 v26, v30
    v_permlane32_swap_b32 v27, v31
    v_permlane32_swap_b32 v32, v36
    v_permlane32_swap_b32 v33, v37
    v_permlane32_swap_b32 v34, v38
    v_permlane32_swap_b32 v35, v39
    v_permlane32_swap_b32 v40, v44
    v_permlane32_swap_b32 v41, v45
    v_permlane32_swap_b32 v42, v46
    v_permlane32_swap_b32 v43, v47
    v_add_f32 v8, v8, v12
    v_add_f32 v9, v9, v13
    v_add_f32 v10, v10, v14
    v_add_f32 v11, v11, v15
    v_add_f32 v16, v16, v20
    v_add_f32 v17, v17, v21
    v_add_f32 v18, v18, v22
    v_add_f32 v19, v19, v23
    v_add_f32 v24, v24, v28
    v_add_f32 v25, v25, v29
    v_add_f32 v26, v26, v30
    v_add_f32 v27, v27, v31
    v_add_f32 v32, v32, v36
    v_add_f32 v33, v33, v37
    v_add_f32 v34, v34, v38
    v_add_f32 v35, v35, v39
    v_add_f32 v40, v40, v44
    v_add_f32 v41, v41, v45
    v_add_f32 v42, v42, v46
    v_add_f32 v43, v43, v47
    v_permlane16_swap_b32 v8, v10
    v_permlane16_swap_b32 v9, v11
    v_permlane16_swap_b32 v16, v18
    v_permlane16_swap_b32 v17, v19
    v_permlane16_swap_b32 v24, v26
    v_permlane16_swap_b32 v25, v27
    v_permlane16_swap_b32 v32, v34
    v_permlane16_swap_b32 v33, v35
    v_permlane16_swap_b32 v40, v42
    v_permlane16_swap_b32 v41, v43
    v_add_f32 v8, v8, v10
    v_add_f32 v9, v9, v11
    v_add_f32 v16, v16, v18
    v_add_f32 v17, v17, v19
    v_add_f32 v24, v24, v26
    v_add_f32 v25, v25, v27
    v_add_f32 v32, v32, v34
    v_add_f32 v33, v33, v35
    v_add_f32 v40, v40, v42
    v_add_f32 v41, v41, v43
    v_add_f32_dpp v8, v8, v8 row_ror:8 row_mask:0xf bank_mask:0x3
    v_add_f32_dpp v16, v16, v16 row_ror:8 row_mask:0xf bank_mask:0x3
    v_add_f32_dpp v24, v24, v24 row_ror:8 row_mask:0xf bank_mask:0x3
    v_add_f32_dpp v32, v32, v32 row_ror:8 row_mask:0xf bank_mask:0x3
    v_add_f32_dpp v40, v40, v40 row_ror:8 row_mask:0xf bank_mask:0x3
    v_add_f32_dpp v8, v9, v9 row_ror:8 row_mask:0xf bank_mask:0xc
    v_add_f32_dpp v16, v17, v17 row_ror:8 row_mask:0xf bank_mask:0xc
    v_add_f32_dpp v24, v25, v25 row_ror:8 row_mask:0xf bank_mask:0xc
    v_add_f32_dpp v32, v33, v33 row_ror:8 row_mask:0xf bank_mask:0xc
    v_add_f32_dpp v40, v41, v41 row_ror:8 row_mask:0xf bank_mask:0xc
    s_mul_i32 s67, s3, 1280
    v_lshl_add_u32 v4, v0, 2, s67
    ds_write_b32 v4, v8 offset:36544
    ds_write_b32 v4, v16 offset:36800
    ds_write_b32 v4, v24 offset:37056
    ds_write_b32 v4, v32 offset:37312
    ds_write_b32 v4, v40 offset:37568
    v_mov_b32 v5, 0
    v_mov_b32 v6, 1
    s_mov_b64 exec, 1
    ds_add_u32 v5, v6 offset:46528
    s_mov_b64 exec, -1
    s_cmp_eq_u32 s3, 4
    s_cbranch_scc1 L_svc
    s_waitcnt vmcnt(5)
    buffer_load_dwordx4 v[108:111], v1, s[8:11], s60 offen offset:128 nt
    s_waitcnt vmcnt(5)
    buffer_load_dwordx4 v[112:115], v1, s[8:11], s60 offen offset:256 nt
    s_add_u32 s60, s60, 786432
    s_waitcnt vmcnt(5)
    buffer_load_dwordx4 v[116:119], v1, s[8:11], s60 offen offset:0 nt
    s_waitcnt vmcnt(5)
    buffer_load_dwordx4 v[120:123], v1, s[8:11], s60 offen offset:128 nt
    s_waitcnt vmcnt(5)
    buffer_load_dwordx4 v[124:127], v1, s[8:11], s60 offen offset:256 nt
    s_add_u32 s60, s60, 786432
    s_waitcnt vmcnt(5)
    buffer_load_dwordx4 v[128:131], v1, s[8:11], s60 offen offset:0 nt
    s_waitcnt vmcnt(5)
    buffer_load_dwordx4 v[132:135], v1, s[8:11], s60 offen offset:128 nt
    s_waitcnt vmcnt(5)
    buffer_load_dwordx4 v[136:139], v1, s[8:11], s60 offen offset:256 nt
    s_add_u32 s60, s60, 786432
    s_waitcnt vmcnt(5)
    buffer_load_dwordx4 v[140:143], v1, s[8:11], s60 offen offset:0 nt
    s_waitcnt vmcnt(5)
    buffer_load_dwordx4 v[144:147], v1, s[8:11], s60 offen offset:128 nt
    s_waitcnt vmcnt(5)
    buffer_load_dwordx4 v[148:151], v1, s[8:11], s60 offen offset:256 nt
    s_add_u32 s60, s60, 786432
    s_waitcnt vmcnt(5)
    buffer_load_dwordx4 v[152:155], v1, s[8:11], s60 offen offset:0 nt
    s_waitcnt vmcnt(5)
    buffer_load_dwordx4 v[156:159], v1, s[8:11], s60 offen offset:128 nt
    v_mov_b32 v6, 64
    s_mov_b64 exec, 1
    ds_add_u32 v5, v6 offset:46528
    s_mov_b64 exec, -1
    s_waitcnt vmcnt(5)
    buffer_load_dwordx4 v[160:163], v1, s[8:11], s60 offen offset:256 nt
    s_add_u32 s60, s60, 786432
    s_waitcnt vmcnt(5)
    buffer_load_dwordx4 v[164:167], v1, s[8:11], s60 offen offset:0 nt
    s_waitcnt vmcnt(5)
    buffer_load_dwordx4 v[168:171], v1, s[8:11], s60 offen offset:128 nt
    s_waitcnt vmcnt(5)
    buffer_load_dwordx4 v[172:175], v1, s[8:11], s60 offen offset:256 nt
    s_add_u32 s60, s60, 786432
    s_waitcnt vmcnt(5)
    buffer_load_dwordx4 v[176:179], v1, s[8:11], s60 offen offset:0 nt
    s_waitcnt vmcnt(5)
    buffer_load_dwordx4 v[180:183], v1, s[8:11], s60 offen offset:128 nt
    s_waitcnt vmcnt(5)
    buffer_load_dwordx4 v[184:187], v1, s[8:11], s60 offen offset:256 nt
    s_add_u32 s60, s60, 786432
    s_waitcnt vmcnt(5)
    buffer_load_dwordx4 v[188:191], v1, s[8:11], s60 offen offset:0 nt
    s_waitcnt vmcnt(5)
    buffer_load_dwordx4 v[192:195], v1, s[8:11], s60 offen offset:128 nt
    s_waitcnt vmcnt(5)
    buffer_load_dwordx4 v[196:199], v1, s[8:11], s60 offen offset:256 nt
    s_mov_b32 s62, 1
    s_add_u32 s60, s60, 786432
    s_waitcnt vmcnt(5)
    buffer_load_dwordx4 v[56:59], v1, s[8:11], s60 offen offset:0 nt
    s_waitcnt vmcnt(5)
    buffer_load_dwordx4 v[60:63], v1, s[8:11], s60 offen offset:128 nt
    s_waitcnt vmcnt(5)
    buffer_load_dwordx4 v[64:67], v1, s[8:11], s60 offen offset:256 nt
    s_add_u32 s60, s60, 786432
    s_waitcnt vmcnt(5)
    buffer_load_dwordx4 v[68:71], v1, s[8:11], s60 offen offset:0 nt
    s_waitcnt vmcnt(5)
    buffer_load_dwordx4 v[72:75], v1, s[8:11], s60 offen offset:128 nt
    s_waitcnt vmcnt(5)
    buffer_load_dwordx4 v[76:79], v1, s[8:11], s60 offen offset:256 nt
    v_lshlrev_b32 v4, 4, v3
    v_add_u32 v4, 42944, v4
    s_lshl_b32 s67, s3, 12
    s_add_u32 s67, s67, 46592
    v_lshl_add_u32 v5, v0, 2, s67
    s_lshl_b32 s67, s65, 2
    s_add_u32 s67, s67, s3
    s_mul_i32 s67, s67, 4224
    s_add_u32 s67, s67, 262144
    s_add_u32 s28, s58, s67
    s_addc_u32 s29, s59, 0
    s_mov_b32 s30, 132
    v_lshlrev_b32 v54, 2, v0
    v_mov_b32 v55, 0x1000
    v_cmp_eq_u32 vcc, s66, v0
    s_nop 1
    v_cndmask_b32 v55, v55, v54, vcc
    v_mov_b32 v52, s46
    s_getreg_b32 s72, hwreg(HW_REG_XCC_ID)
    s_bitcmp1_b32 s72, 0
    s_cselect_b32 s72, 26, 22
    s_add_u32 s67, s3, s71
    s_cmp_eq_u32 s67, 4
    s_cselect_b32 s22, 0, s22
    s_cselect_b32 s80, 0, s80
    s_cselect_b32 s81, 0, s81
    s_cselect_b32 s82, 0, s82
    s_lshr_b32 s67, s6, 1
    s_sub_u32 s83, 11, s67
    s_mul_i32 s67, s67, -24379392
    s_add_u32 s75, s61, s67
    s_add_u32 s75, s75, 251658240
    s_mov_b32 s74, 786432
    s_mov_b64 vcc, 0
    s_mov_b32 s47, 0
    s_barrier
    ds_read_b128 v[32:35], v4 offset:0
    ds_read_b128 v[36:39], v4 offset:128
    ds_read_b128 v[40:43], v4 offset:256
    s_waitcnt lgkmcnt(0)
    s_mov_b32 s63, 1
    s_add_u32 s60, s60, s74
    s_cbranch_vccnz L_dp1
    s_waitcnt vmcnt(4)
L_dp1:
    s_waitcnt vmcnt(5)
    buffer_load_dwordx4 v[80:83], v1, s[8:11], s60 offen offset:0 nt
    v_add_u32 v52, 1, v52
    buffer_store_dword v52, v55, s[28:31], 0 offen
    buffer_load_dword v53, v54, s[28:31], 0 offen nt
    v_dot2_f32_bf16 v16, v104, v32, 0
    v_dot2_f32_bf16 v16, v105, v33, v16
    v_dot2_f32_bf16 v16, v106, v34, v16
    v_dot2_f32_bf16 v16, v107, v35, v16
    v_dot2_f32_bf16 v8, v56, v32, 0
    v_dot2_f32_bf16 v8, v57, v33, v8
    v_dot2_f32_bf16 v8, v58, v34, v8
    v_dot2_f32_bf16 v8, v59, v35, v8
    s_cbranch_vccnz L_dp2
    s_waitcnt vmcnt(6)
L_dp2:
    s_waitcnt vmcnt(7)
    buffer_load_dwordx4 v[84:87], v1, s[8:11], s60 offen offset:128 nt
    v_dot2_f32_bf16 v16, v108, v36, v16
    v_dot2_f32_bf16 v16, v109, v37, v16
    v_dot2_f32_bf16 v16, v110, v38, v16
    v_dot2_f32_bf16 v16, v111, v39, v16
    v_dot2_f32_bf16 v8, v60, v36, v8
    v_dot2_f32_bf16 v8, v61, v37, v8
    v_dot2_f32_bf16 v8, v62, v38, v8
    v_dot2_f32_bf16 v8, v63, v39, v8
    s_cbranch_vccnz L_dp3
    s_waitcnt vmcnt(6)
L_dp3:
    s_waitcnt vmcnt(7)
    buffer_load_dwordx4 v[56:59], v1, s[8:11], s60 offen offset:256 nt
    v_dot2_f32_bf16 v16, v112, v40, v16
    v_dot2_f32_bf16 v16, v113, v41, v16
    v_dot2_f32_bf16 v16, v114, v42, v16
    v_dot2_f32_bf16 v16, v115, v43, v16
    v_dot2_f32_bf16 v8, v64, v40, v8
    v_dot2_f32_bf16 v8, v65, v41, v8
    v_dot2_f32_bf16 v8, v66, v42, v8
    v_dot2_f32_bf16 v8, v67, v43, v8
    s_add_u32 s60, s60, s74
    s_cbranch_vccnz L_dp4
    s_waitcnt vmcnt(6)
L_dp4:
    s_waitcnt vmcnt(7)
    buffer_load_dwordx4 v[60:63], v1, s[8:11], s60 offen offset:0 nt
    v_dot2_f32_bf16 v17, v116, v32, 0
    v_dot2_f32_bf16 v17, v117, v33, v17
    v_dot2_f32_bf16 v17, v118, v34, v17
    v_dot2_f32_bf16 v17, v119, v35, v17
    v_add_f32_dpp v10, v8, v8 row_half_mirror row_mask:0xf bank_mask:0x5
    v_dot2_f32_bf16 v9, v68, v32, 0
    v_dot2_f32_bf16 v9, v69, v33, v9
    v_dot2_f32_bf16 v9, v70, v34, v9
    v_dot2_f32_bf16 v9, v71, v35, v9
    s_cbranch_vccnz L_dp5
    s_waitcnt vmcnt(6)
L_dp5:
    s_waitcnt vmcnt(7)
    buffer_load_dwordx4 v[64:67], v1, s[8:11], s60 offen offset:128 nt
    v_dot2_f32_bf16 v17, v120, v36, v17
    v_dot2_f32_bf16 v17, v121, v37, v17
    v_dot2_f32_bf16 v17, v122, v38, v17
    v_dot2_f32_bf16 v17, v123, v39, v17
    v_dot2_f32_bf16 v9, v72, v36, v9
    v_dot2_f32_bf16 v9, v73, v37, v9
    v_dot2_f32_bf16 v9, v74, v38, v9
    v_dot2_f32_bf16 v9, v75, v39, v9
    s_cbranch_vccnz L_dp6
    s_waitcnt vmcnt(6)
L_dp6:
    s_waitcnt vmcnt(7)
    buffer_load_dwordx4 v[68:71], v1, s[8:11], s60 offen offset:256 nt
    v_dot2_f32_bf16 v17, v124, v40, v17
    v_dot2_f32_bf16 v17, v125, v41, v17
    v_dot2_f32_bf16 v17, v126, v42, v17
    v_dot2_f32_bf16 v17, v127, v43, v17
    v_dot2_f32_bf16 v9, v76, v40, v9
    v_dot2_f32_bf16 v9, v77, v41, v9
    v_dot2_f32_bf16 v9, v78, v42, v9
    v_dot2_f32_bf16 v9, v79, v43, v9
    s_add_u32 s60, s60, s74
    s_cbranch_vccnz L_dp7
    s_waitcnt vmcnt(4)
L_dp7:
    s_waitcnt vmcnt(7)
    buffer_load_dwordx4 v[72:75], v1, s[8:11], s60 offen offset:0 nt
    v_dot2_f32_bf16 v18, v128, v32, 0
    v_dot2_f32_bf16 v18, v129, v33, v18
    v_dot2_f32_bf16 v18, v130, v34, v18
    v_dot2_f32_bf16 v18, v131, v35, v18
    v_add_f32_dpp v11, v9, v9 row_half_mirror row_mask:0xf bank_mask:0x5
    v_dot2_f32_bf16 v8, v80, v32, 0
    v_dot2_f32_bf16 v8, v81, v33, v8
    v_dot2_f32_bf16 v8, v82, v34, v8
    v_dot2_f32_bf16 v8, v83, v35, v8
    s_cbranch_vccnz L_dp8
    s_waitcnt vmcnt(4)
L_dp8:
    s_waitcnt vmcnt(5)
    buffer_load_dwordx4 v[76:79], v1, s[8:11], s60 offen offset:128 nt
    v_readlane_b32 s68, v53, 32
    s_nop 0
    s_sub_u32 s68, s68, s46
    s_cmp_lt_u32 s68, 33
    s_cselect_b32 s72, s68, s72
    v_sub_u32 v53, v53, v52
    v_cmp_gt_u32 vcc, 64, v53
    s_nop 0
    s_bcnt1_i32_b32 s67, vcc_lo
    s_cmp_gt_u32 s67, s72
    s_cselect_b64 vcc, -1, 0
    v_dot2_f32_bf16 v18, v132, v36, v18
    v_dot2_f32_bf16 v18, v133, v37, v18
    v_dot2_f32_bf16 v18, v134, v38, v18
    v_dot2_f32_bf16 v18, v135, v39, v18
    v_dot2_f32_bf16 v8, v84, v36, v8
    v_dot2_f32_bf16 v8, v85, v37, v8
    v_dot2_f32_bf16 v8, v86, v38, v8
    v_dot2_f32_bf16 v8, v87, v39, v8
    s_cbranch_vccnz L_dp9
    s_waitcnt vmcnt(4)
L_dp9:
    s_waitcnt vmcnt(5)
    buffer_load_dwordx4 v[80:83], v1, s[8:11], s60 offen offset:256 nt
    v_add_u32 v52, 1, v52
    buffer_store_dword v52, v55, s[28:31], 0 offen
    buffer_load_dword v53, v54, s[28:31], 0 offen nt
    v_dot2_f32_bf16 v18, v136, v40, v18
    v_dot2_f32_bf16 v18, v137, v41, v18
    v_dot2_f32_bf16 v18, v138, v42, v18
    v_dot2_f32_bf16 v18, v139, v43, v18
    v_dot2_f32_bf16 v8, v56, v40, v8
    v_dot2_f32_bf16 v8, v57, v41, v8
    v_dot2_f32_bf16 v8, v58, v42, v8
    v_dot2_f32_bf16 v8, v59, v43, v8
    s_add_u32 s60, s60, s74
    s_cbranch_vccnz L_dp10
    s_waitcnt vmcnt(6)
L_dp10:
    s_waitcnt vmcnt(7)
    buffer_load_dwordx4 v[84:87], v1, s[8:11], s60 offen offset:0 nt
    v_dot2_f32_bf16 v19, v140, v32, 0
    v_dot2_f32_bf16 v19, v141, v33, v19
    v_dot2_f32_bf16 v19, v142, v34, v19
    v_dot2_f32_bf16 v19, v143, v35, v19
    v_add_f32_dpp v12, v8, v8 row_half_mirror row_mask:0xf bank_mask:0x5
    v_dot2_f32_bf16 v9, v60, v32, 0
    v_dot2_f32_bf16 v9, v61, v33, v9
    v_dot2_f32_bf16 v9, v62, v34, v9
    v_dot2_f32_bf16 v9, v63, v35, v9
    s_cbranch_vccnz L_dp11
    s_waitcnt vmcnt(6)
L_dp11:
    s_waitcnt vmcnt(7)
    buffer_load_dwordx4 v[56:59], v1, s[8:11], s60 offen offset:128 nt
    v_dot2_f32_bf16 v19, v144, v36, v19
    v_dot2_f32_bf16 v19, v145, v37, v19
    v_dot2_f32_bf16 v19, v146, v38, v19
    v_dot2_f32_bf16 v19, v147, v39, v19
    v_dot2_f32_bf16 v9, v64, v36, v9
    v_dot2_f32_bf16 v9, v65, v37, v9
    v_dot2_f32_bf16 v9, v66, v38, v9
    v_dot2_f32_bf16 v9, v67, v39, v9
    s_cbranch_vccnz L_dp12
    s_waitcnt vmcnt(6)
L_dp12:
    s_waitcnt vmcnt(7)
    buffer_load_dwordx4 v[60:63], v1, s[8:11], s60 offen offset:256 nt
    v_dot2_f32_bf16 v19, v148, v40, v19
    v_dot2_f32_bf16 v19, v149, v41, v19
    v_dot2_f32_bf16 v19, v150, v42, v19
    v_dot2_f32_bf16 v19, v151, v43, v19
    v_dot2_f32_bf16 v9, v68, v40, v9
    v_dot2_f32_bf16 v9, v69, v41, v9
    v_dot2_f32_bf16 v9, v70, v42, v9
    v_dot2_f32_bf16 v9, v71, v43, v9
    s_add_u32 s60, s60, s74
    s_cbranch_vccnz L_dp13
    s_waitcnt vmcnt(6)
L_dp13:
    s_waitcnt vmcnt(7)
    buffer_load_dwordx4 v[64:67], v1, s[8:11], s60 offen offset:0 nt
    v_dot2_f32_bf16 v20, v152, v32, 0
    v_dot2_f32_bf16 v20, v153, v33, v20
    v_dot2_f32_bf16 v20, v154, v34, v20
    v_dot2_f32_bf16 v20, v155, v35, v20
    v_add_f32_dpp v13, v9, v9 row_half_mirror row_mask:0xf bank_mask:0x5
    v_dot2_f32_bf16 v8, v72, v32, 0
    v_dot2_f32_bf16 v8, v73, v33, v8
    v_dot2_f32_bf16 v8, v74, v34, v8
    v_dot2_f32_bf16 v8, v75, v35, v8
    s_cbranch_vccnz L_dp14
    s_waitcnt vmcnt(6)
L_dp14:
    s_waitcnt vmcnt(7)
    buffer_load_dwordx4 v[68:71], v1, s[8:11], s60 offen offset:128 nt
    v_dot2_f32_bf16 v20, v156, v36, v20
    v_dot2_f32_bf16 v20, v157, v37, v20
    v_dot2_f32_bf16 v20, v158, v38, v20
    v_dot2_f32_bf16 v20, v159, v39, v20
    v_dot2_f32_bf16 v8, v76, v36, v8
    v_dot2_f32_bf16 v8, v77, v37, v8
    v_dot2_f32_bf16 v8, v78, v38, v8
    v_dot2_f32_bf16 v8, v79, v39, v8
    s_cbranch_vccnz L_dp15
    s_waitcnt vmcnt(4)
L_dp15:
    s_waitcnt vmcnt(7)
    buffer_load_dwordx4 v[72:75], v1, s[8:11], s60 offen offset:256 nt
    v_dot2_f32_bf16 v20, v160, v40, v20
    v_dot2_f32_bf16 v20, v161, v41, v20
    v_dot2_f32_bf16 v20, v162, v42, v20
    v_dot2_f32_bf16 v20, v163, v43, v20
    v_dot2_f32_bf16 v8, v80, v40, v8
    v_dot2_f32_bf16 v8, v81, v41, v8
    v_dot2_f32_bf16 v8, v82, v42, v8
    v_dot2_f32_bf16 v8, v83, v43, v8
    s_add_u32 s60, s60, s74
    s_cbranch_vccnz L_dp16
    s_waitcnt vmcnt(4)
L_dp16:
    s_waitcnt vmcnt(5)
    buffer_load_dwordx4 v[76:79], v1, s[8:11], s60 offen offset:0 nt
    v_readlane_b32 s68, v53, 32
    s_nop 0
    s_sub_u32 s68, s68, s46
    s_cmp_lt_u32 s68, 33
    s_cselect_b32 s72, s68, s72
    v_sub_u32 v53, v53, v52
    v_cmp_gt_u32 vcc, 64, v53
    s_nop 0
    s_bcnt1_i32_b32 s67, vcc_lo
    s_cmp_gt_u32 s67, s72
    s_cselect_b64 vcc, -1, 0
    v_dot2_f32_bf16 v21, v164, v32, 0
    v_dot2_f32_bf16 v21, v165, v33, v21
    v_dot2_f32_bf16 v21, v166, v34, v21
    v_dot2_f32_bf16 v21, v167, v35, v21
    v_add_f32_dpp v10, v8, v8 row_half_mirror row_mask:0xf bank_mask:0xa
    v_dot2_f32_bf16 v9, v84, v32, 0
    v_dot2_f32_bf16 v9, v85, v33, v9
    v_dot2_f32_bf16 v9, v86, v34, v9
    v_dot2_f32_bf16 v9, v87, v35, v9
    s_cbranch_vccnz L_dp17
    s_waitcnt vmcnt(4)
L_dp17:
    s_waitcnt vmcnt(5)
    buffer_load_dwordx4 v[80:83], v1, s[8:11], s60 offen offset:128 nt
    v_add_u32 v52, 1, v52
    buffer_store_dword v52, v55, s[28:31], 0 offen
    buffer_load_dword v53, v54, s[28:31], 0 offen nt
    v_dot2_f32_bf16 v21, v168, v36, v21
    v_dot2_f32_bf16 v21, v169, v37, v21
    v_dot2_f32_bf16 v21, v170, v38, v21
    v_dot2_f32_bf16 v21, v171, v39, v21
    v_add_f32_dpp v10, v10, v10 quad_perm:[2,3,0,1] row_mask:0xf bank_mask:0xf
    v_dot2_f32_bf16 v9, v56, v36, v9
    v_dot2_f32_bf16 v9, v57, v37, v9
    v_dot2_f32_bf16 v9, v58, v38, v9
    v_dot2_f32_bf16 v9, v59, v39, v9
    s_cbranch_vccnz L_dp18
    s_waitcnt vmcnt(6)
L_dp18:
    s_waitcnt vmcnt(7)
    buffer_load_dwordx4 v[84:87], v1, s[8:11], s60 offen offset:256 nt
    v_dot2_f32_bf16 v21, v172, v40, v21
    v_dot2_f32_bf16 v21, v173, v41, v21
    v_dot2_f32_bf16 v21, v174, v42, v21
    v_dot2_f32_bf16 v21, v175, v43, v21
    v_dot2_f32_bf16 v9, v60, v40, v9
    v_dot2_f32_bf16 v9, v61, v41, v9
    v_dot2_f32_bf16 v9, v62, v42, v9
    v_dot2_f32_bf16 v9, v63, v43, v9
    s_add_u32 s60, s60, s74
    s_add_u32 s62, s62, 1
    s_sub_u32 s67, s62, 10
    s_cmp_gt_u32 s67, 1
    s_cbranch_scc1 L_n520
    s_mul_i32 s67, s67, 25165824
    s_add_u32 s60, s75, s67
    s_mov_b32 s74, 1572864
    s_branch L_nb20
L_n520:
    s_and_b32 s67, s62, 1
    s_cbranch_scc1 L_nb20
    s_mov_b32 s74, 786432
    s_mul_i32 s60, s62, 25165824
    s_add_u32 s60, s60, s61
    s_cmp_lg_u32 s62, 16
    s_cbranch_scc1 L_nb20
    s_mov_b64 s[8:9], s[40:41]
    s_add_u32 s60, s61, 301989888
L_nb20:
    s_cbranch_vccnz L_dp19
    s_waitcnt vmcnt(6)
L_dp19:
    s_waitcnt vmcnt(7)
    buffer_load_dwordx4 v[56:59], v1, s[8:11], s60 offen offset:0 nt
    v_dot2_f32_bf16 v22, v176, v32, 0
    v_dot2_f32_bf16 v22, v177, v33, v22
    v_dot2_f32_bf16 v22, v178, v34, v22
    v_dot2_f32_bf16 v22, v179, v35, v22
    v_add_f32_dpp v11, v9, v9 row_half_mirror row_mask:0xf bank_mask:0xa
    v_dot2_f32_bf16 v8, v64, v32, 0
    v_dot2_f32_bf16 v8, v65, v33, v8
    v_dot2_f32_bf16 v8, v66, v34, v8
    v_dot2_f32_bf16 v8, v67, v35, v8
    s_cbranch_vccnz L_dp21
    s_waitcnt vmcnt(6)
L_dp21:
    s_waitcnt vmcnt(7)
    buffer_load_dwordx4 v[60:63], v1, s[8:11], s60 offen offset:128 nt
    v_dot2_f32_bf16 v22, v180, v36, v22
    v_dot2_f32_bf16 v22, v181, v37, v22
    v_dot2_f32_bf16 v22, v182, v38, v22
    v_dot2_f32_bf16 v22, v183, v39, v22
    v_add_f32_dpp v11, v11, v11 quad_perm:[2,3,0,1] row_mask:0xf bank_mask:0xf
    v_dot2_f32_bf16 v8, v68, v36, v8
    v_dot2_f32_bf16 v8, v69, v37, v8
    v_dot2_f32_bf16 v8, v70, v38, v8
    v_dot2_f32_bf16 v8, v71, v39, v8
    s_cbranch_vccnz L_dp22
    s_waitcnt vmcnt(6)
L_dp22:
    s_waitcnt vmcnt(7)
    buffer_load_dwordx4 v[64:67], v1, s[8:11], s60 offen offset:256 nt
    v_dot2_f32_bf16 v22, v184, v40, v22
    v_dot2_f32_bf16 v22, v185, v41, v22
    v_dot2_f32_bf16 v22, v186, v42, v22
    v_dot2_f32_bf16 v22, v187, v43, v22
    s_add_u32 s63, s63, 1
    s_lshr_b32 s67, s63, 1
    s_cmp_eq_u32 s63, s83
    s_cselect_b32 s67, 8, s67
    s_mul_i32 s67, s67, 384
    v_add_u32 v51, s67, v4
    v_dot2_f32_bf16 v8, v72, v40, v8
    v_dot2_f32_bf16 v8, v73, v41, v8
    v_dot2_f32_bf16 v8, v74, v42, v8
    v_dot2_f32_bf16 v8, v75, v43, v8
    s_add_u32 s60, s60, s74
    s_cbranch_vccnz L_dp23
    s_waitcnt vmcnt(6)
L_dp23:
    s_waitcnt vmcnt(7)
    buffer_load_dwordx4 v[68:71], v1, s[8:11], s60 offen offset:0 nt
    v_dot2_f32_bf16 v23, v188, v32, 0
    v_dot2_f32_bf16 v23, v189, v33, v23
    v_dot2_f32_bf16 v23, v190, v34, v23
    v_dot2_f32_bf16 v23, v191, v35, v23
    v_add_f32_dpp v12, v8, v8 row_half_mirror row_mask:0xf bank_mask:0xa
    v_dot2_f32_bf16 v9, v76, v32, 0
    v_dot2_f32_bf16 v9, v77, v33, v9
    v_dot2_f32_bf16 v9, v78, v34, v9
    v_dot2_f32_bf16 v9, v79, v35, v9
    ds_read_b128 v[32:35], v51 offset:0
    s_cbranch_vccnz L_dp24
    s_waitcnt vmcnt(4)
L_dp24:
    s_waitcnt vmcnt(7)
    buffer_load_dwordx4 v[72:75], v1, s[8:11], s60 offen offset:128 nt
    v_dot2_f32_bf16 v23, v192, v36, v23
    v_dot2_f32_bf16 v23, v193, v37, v23
    v_dot2_f32_bf16 v23, v194, v38, v23
    v_dot2_f32_bf16 v23, v195, v39, v23
    v_add_f32_dpp v12, v12, v12 quad_perm:[2,3,0,1] row_mask:0xf bank_mask:0xf
    v_dot2_f32_bf16 v9, v80, v36, v9
    v_dot2_f32_bf16 v9, v81, v37, v9
    v_dot2_f32_bf16 v9, v82, v38, v9
    v_dot2_f32_bf16 v9, v83, v39, v9
    ds_read_b128 v[36:39], v51 offset:128
    s_cbranch_vccnz L_dp25
    s_waitcnt vmcnt(4)
L_dp25:
    s_waitcnt vmcnt(5)
    buffer_load_dwordx4 v[76:79], v1, s[8:11], s60 offen offset:256 nt
    v_readlane_b32 s68, v53, 32
    s_nop 0
    s_sub_u32 s68, s68, s46
    s_cmp_lt_u32 s68, 33
    s_cselect_b32 s72, s68, s72
    v_sub_u32 v53, v53, v52
    v_cmp_gt_u32 vcc, 64, v53
    s_nop 0
    s_bcnt1_i32_b32 s67, vcc_lo
    s_cmp_gt_u32 s67, s72
    s_cselect_b64 vcc, -1, 0
    v_dot2_f32_bf16 v23, v196, v40, v23
    v_dot2_f32_bf16 v23, v197, v41, v23
    v_dot2_f32_bf16 v23, v198, v42, v23
    v_dot2_f32_bf16 v23, v199, v43, v23
    v_cndmask_b32 v14, v10, v12, s[12:13]
    v_dot2_f32_bf16 v9, v84, v40, v9
    v_dot2_f32_bf16 v9, v85, v41, v9
    v_dot2_f32_bf16 v9, v86, v42, v9
    v_dot2_f32_bf16 v9, v87, v43, v9
    v_add_f32_dpp v14, v14, v14 quad_perm:[1,0,3,2] row_mask:0xf bank_mask:0xf
    ds_read_b128 v[40:43], v51 offset:256
    v_add_f32_dpp v16, v16, v16 row_half_mirror row_mask:0xf bank_mask:0x5
    v_add_f32_dpp v17, v17, v17 row_half_mirror row_mask:0xf bank_mask:0x5
    v_add_f32_dpp v18, v18, v18 row_half_mirror row_mask:0xf bank_mask:0x5
    v_add_f32_dpp v19, v19, v19 row_half_mirror row_mask:0xf bank_mask:0x5
    v_add_f32_dpp v16, v20, v20 row_half_mirror row_mask:0xf bank_mask:0xa
    v_add_f32_dpp v17, v21, v21 row_half_mirror row_mask:0xf bank_mask:0xa
    v_add_f32_dpp v18, v22, v22 row_half_mirror row_mask:0xf bank_mask:0xa
    v_add_f32_dpp v19, v23, v23 row_half_mirror row_mask:0xf bank_mask:0xa
    v_add_f32_dpp v16, v16, v16 quad_perm:[2,3,0,1] row_mask:0xf bank_mask:0xf
    v_add_f32_dpp v17, v17, v17 quad_perm:[2,3,0,1] row_mask:0xf bank_mask:0xf
    v_add_f32_dpp v18, v18, v18 quad_perm:[2,3,0,1] row_mask:0xf bank_mask:0xf
    v_add_f32_dpp v19, v19, v19 quad_perm:[2,3,0,1] row_mask:0xf bank_mask:0xf
    v_cndmask_b32 v16, v16, v18, s[12:13]
    v_cndmask_b32 v17, v17, v19, s[12:13]
    s_nop 0
    v_add_f32_dpp v16, v16, v16 quad_perm:[1,0,3,2] row_mask:0xf bank_mask:0xf
    v_add_f32_dpp v17, v17, v17 quad_perm:[1,0,3,2] row_mask:0xf bank_mask:0xf
    v_cndmask_b32 v16, v16, v17, s[14:15]
    ds_write_b32 v5, v16
    v_add_u32 v5, 256, v5
L_k:
    s_add_u32 s60, s60, s74
    s_cbranch_vccnz L_dp26
    s_waitcnt vmcnt(4)
L_dp26:
    s_waitcnt vmcnt(5)
    buffer_load_dwordx4 v[80:83], v1, s[8:11], s60 offen offset:0 nt
    v_add_u32 v52, 1, v52
    buffer_store_dword v52, v55, s[28:31], 0 offen
    buffer_load_dword v53, v54, s[28:31], 0 offen nt
    v_add_f32_dpp v13, v9, v9 row_half_mirror row_mask:0xf bank_mask:0xa
    s_nop 1
    v_add_f32_dpp v13, v13, v13 quad_perm:[2,3,0,1] row_mask:0xf bank_mask:0xf
    v_cndmask_b32 v15, v11, v13, s[12:13]
    s_waitcnt lgkmcnt(0)
    v_dot2_f32_bf16 v8, v56, v32, 0
    v_dot2_f32_bf16 v8, v57, v33, v8
    v_dot2_f32_bf16 v8, v58, v34, v8
    v_dot2_f32_bf16 v8, v59, v35, v8
    s_cbranch_vccnz L_dp27
    s_waitcnt vmcnt(6)
L_dp27:
    s_waitcnt vmcnt(7)
    buffer_load_dwordx4 v[84:87], v1, s[8:11], s60 offen offset:128 nt
    v_add_f32_dpp v15, v15, v15 quad_perm:[1,0,3,2] row_mask:0xf bank_mask:0xf
    v_cndmask_b32 v14, v14, v15, s[14:15]
    ds_write_b32 v5, v14
    v_add_u32 v5, 256, v5
    v_dot2_f32_bf16 v8, v60, v36, v8
    v_dot2_f32_bf16 v8, v61, v37, v8
    v_dot2_f32_bf16 v8, v62, v38, v8
    v_dot2_f32_bf16 v8, v63, v39, v8
    s_cbranch_vccnz L_dp28
    s_waitcnt vmcnt(6)
L_dp28:
    s_waitcnt vmcnt(7)
    buffer_load_dwordx4 v[56:59], v1, s[8:11], s60 offen offset:256 nt
    s_waitcnt lgkmcnt(0)
    s_barrier
    v_dot2_f32_bf16 v8, v64, v40, v8
    v_dot2_f32_bf16 v8, v65, v41, v8
    v_dot2_f32_bf16 v8, v66, v42, v8
    v_dot2_f32_bf16 v8, v67, v43, v8
    s_add_u32 s60, s60, s74
    s_cbranch_vccnz L_dp29
    s_waitcnt vmcnt(6)
L_dp29:
    s_waitcnt vmcnt(7)
    buffer_load_dwordx4 v[60:63], v1, s[8:11], s60 offen offset:0 nt
    v_add_f32_dpp v10, v8, v8 row_half_mirror row_mask:0xf bank_mask:0x5
    v_dot2_f32_bf16 v9, v68, v32, 0
    v_dot2_f32_bf16 v9, v69, v33, v9
    v_dot2_f32_bf16 v9, v70, v34, v9
    v_dot2_f32_bf16 v9, v71, v35, v9
    s_cbranch_vccnz L_dp30
    s_waitcnt vmcnt(6)
L_dp30:
    s_waitcnt vmcnt(7)
    buffer_load_dwordx4 v[64:67], v1, s[8:11], s60 offen offset:128 nt
    v_dot2_f32_bf16 v9, v72, v36, v9
    v_dot2_f32_bf16 v9, v73, v37, v9
    v_dot2_f32_bf16 v9, v74, v38, v9
    v_dot2_f32_bf16 v9, v75, v39, v9
    s_cbranch_vccnz L_dp31
    s_waitcnt vmcnt(6)
L_dp31:
    s_waitcnt vmcnt(7)
    buffer_load_dwordx4 v[68:71], v1, s[8:11], s60 offen offset:256 nt
    v_dot2_f32_bf16 v9, v76, v40, v9
    v_dot2_f32_bf16 v9, v77, v41, v9
    v_dot2_f32_bf16 v9, v78, v42, v9
    v_dot2_f32_bf16 v9, v79, v43, v9
    s_add_u32 s60, s60, s74
    s_cbranch_vccnz L_dp32
    s_waitcnt vmcnt(4)
L_dp32:
    s_waitcnt vmcnt(7)
    buffer_load_dwordx4 v[72:75], v1, s[8:11], s60 offen offset:0 nt
    v_add_f32_dpp v11, v9, v9 row_half_mirror row_mask:0xf bank_mask:0x5
    v_dot2_f32_bf16 v8, v80, v32, 0
    v_dot2_f32_bf16 v8, v81, v33, v8
    v_dot2_f32_bf16 v8, v82, v34, v8
    v_dot2_f32_bf16 v8, v83, v35, v8
    s_cbranch_vccnz L_dp33
    s_waitcnt vmcnt(4)
L_dp33:
    s_waitcnt vmcnt(5)
    buffer_load_dwordx4 v[76:79], v1, s[8:11], s60 offen offset:128 nt
    v_readlane_b32 s68, v53, 32
    s_nop 0
    s_sub_u32 s68, s68, s46
    s_cmp_lt_u32 s68, 33
    s_cselect_b32 s72, s68, s72
    v_sub_u32 v53, v53, v52
    v_cmp_gt_u32 vcc, 64, v53
    s_nop 0
    s_bcnt1_i32_b32 s67, vcc_lo
    s_cmp_gt_u32 s67, s72
    s_cselect_b64 vcc, -1, 0
    v_dot2_f32_bf16 v8, v84, v36, v8
    v_dot2_f32_bf16 v8, v85, v37, v8
    v_dot2_f32_bf16 v8, v86, v38, v8
    v_dot2_f32_bf16 v8, v87, v39, v8
    s_cbranch_vccnz L_dp34
    s_waitcnt vmcnt(4)
L_dp34:
    s_waitcnt vmcnt(5)
    buffer_load_dwordx4 v[80:83], v1, s[8:11], s60 offen offset:256 nt
    v_add_u32 v52, 1, v52
    buffer_store_dword v52, v55, s[28:31], 0 offen
    buffer_load_dword v53, v54, s[28:31], 0 offen nt
    v_dot2_f32_bf16 v8, v56, v40, v8
    v_dot2_f32_bf16 v8, v57, v41, v8
    v_dot2_f32_bf16 v8, v58, v42, v8
    v_dot2_f32_bf16 v8, v59, v43, v8
    s_add_u32 s60, s60, s74
    s_cbranch_vccnz L_dp35
    s_waitcnt vmcnt(6)
L_dp35:
    s_waitcnt vmcnt(7)
    buffer_load_dwordx4 v[84:87], v1, s[8:11], s60 offen offset:0 nt
    v_add_f32_dpp v12, v8, v8 row_half_mirror row_mask:0xf bank_mask:0x5
    v_dot2_f32_bf16 v9, v60, v32, 0
    v_dot2_f32_bf16 v9, v61, v33, v9
    v_dot2_f32_bf16 v9, v62, v34, v9
    v_dot2_f32_bf16 v9, v63, v35, v9
    s_cbranch_vccnz L_dp36
    s_waitcnt vmcnt(6)
L_dp36:
    s_waitcnt vmcnt(7)
    buffer_load_dwordx4 v[56:59], v1, s[8:11], s60 offen offset:128 nt
    v_dot2_f32_bf16 v9, v64, v36, v9
    v_dot2_f32_bf16 v9, v65, v37, v9
    v_dot2_f32_bf16 v9, v66, v38, v9
    v_dot2_f32_bf16 v9, v67, v39, v9
    s_cbranch_vccnz L_dp37
    s_waitcnt vmcnt(6)
L_dp37:
    s_waitcnt vmcnt(7)
    buffer_load_dwordx4 v[60:63], v1, s[8:11], s60 offen offset:256 nt
    v_dot2_f32_bf16 v9, v68, v40, v9
    v_dot2_f32_bf16 v9, v69, v41, v9
    v_dot2_f32_bf16 v9, v70, v42, v9
    v_dot2_f32_bf16 v9, v71, v43, v9
    s_add_u32 s60, s60, s74
    s_cbranch_vccnz L_dp38
    s_waitcnt vmcnt(6)
L_dp38:
    s_waitcnt vmcnt(7)
    buffer_load_dwordx4 v[64:67], v1, s[8:11], s60 offen offset:0 nt
    v_add_f32_dpp v13, v9, v9 row_half_mirror row_mask:0xf bank_mask:0x5
    v_dot2_f32_bf16 v8, v72, v32, 0
    v_dot2_f32_bf16 v8, v73, v33, v8
    v_dot2_f32_bf16 v8, v74, v34, v8
    v_dot2_f32_bf16 v8, v75, v35, v8
    s_cbranch_vccnz L_dp39
    s_waitcnt vmcnt(6)
L_dp39:
    s_waitcnt vmcnt(7)
    buffer_load_dwordx4 v[68:71], v1, s[8:11], s60 offen offset:128 nt
    v_dot2_f32_bf16 v8, v76, v36, v8
    v_dot2_f32_bf16 v8, v77, v37, v8
    v_dot2_f32_bf16 v8, v78, v38, v8
    v_dot2_f32_bf16 v8, v79, v39, v8
    s_cbranch_vccnz L_dp40
    s_waitcnt vmcnt(4)
L_dp40:
    s_waitcnt vmcnt(7)
    buffer_load_dwordx4 v[72:75], v1, s[8:11], s60 offen offset:256 nt
    v_dot2_f32_bf16 v8, v80, v40, v8
    v_dot2_f32_bf16 v8, v81, v41, v8
    v_dot2_f32_bf16 v8, v82, v42, v8
    v_dot2_f32_bf16 v8, v83, v43, v8
    s_add_u32 s60, s60, s74
    s_cbranch_vccnz L_dp41
    s_waitcnt vmcnt(4)
L_dp41:
    s_waitcnt vmcnt(5)
    buffer_load_dwordx4 v[76:79], v1, s[8:11], s60 offen offset:0 nt
    v_readlane_b32 s68, v53, 32
    s_nop 0
    s_sub_u32 s68, s68, s46
    s_cmp_lt_u32 s68, 33
    s_cselect_b32 s72, s68, s72
    v_sub_u32 v53, v53, v52
    v_cmp_gt_u32 vcc, 64, v53
    s_nop 0
    s_bcnt1_i32_b32 s67, vcc_lo
    s_cmp_gt_u32 s67, s72
    s_cselect_b64 vcc, -1, 0
    v_add_f32_dpp v10, v8, v8 row_half_mirror row_mask:0xf bank_mask:0xa
    v_dot2_f32_bf16 v9, v84, v32, 0
    v_dot2_f32_bf16 v9, v85, v33, v9
    v_dot2_f32_bf16 v9, v86, v34, v9
    v_dot2_f32_bf16 v9, v87, v35, v9
    s_cbranch_vccnz L_dp42
    s_waitcnt vmcnt(4)
L_dp42:
    s_waitcnt vmcnt(5)
    buffer_load_dwordx4 v[80:83], v1, s[8:11], s60 offen offset:128 nt
    v_add_u32 v52, 1, v52
    buffer_store_dword v52, v55, s[28:31], 0 offen
    buffer_load_dword v53, v54, s[28:31], 0 offen nt
    v_add_f32_dpp v10, v10, v10 quad_perm:[2,3,0,1] row_mask:0xf bank_mask:0xf
    v_dot2_f32_bf16 v9, v56, v36, v9
    v_dot2_f32_bf16 v9, v57, v37, v9
    v_dot2_f32_bf16 v9, v58, v38, v9
    v_dot2_f32_bf16 v9, v59, v39, v9
    s_cbranch_vccnz L_dp43
    s_waitcnt vmcnt(6)
L_dp43:
    s_waitcnt vmcnt(7)
    buffer_load_dwordx4 v[84:87], v1, s[8:11], s60 offen offset:256 nt
    v_dot2_f32_bf16 v9, v60, v40, v9
    v_dot2_f32_bf16 v9, v61, v41, v9
    v_dot2_f32_bf16 v9, v62, v42, v9
    v_dot2_f32_bf16 v9, v63, v43, v9
    s_add_u32 s60, s60, s74
    s_add_u32 s62, s62, 1
    s_sub_u32 s67, s62, 10
    s_cmp_gt_u32 s67, 1
    s_cbranch_scc1 L_n545
    s_mul_i32 s67, s67, 25165824
    s_add_u32 s60, s75, s67
    s_mov_b32 s74, 1572864
    s_branch L_nb45
L_n545:
    s_and_b32 s67, s62, 1
    s_cbranch_scc1 L_nb45
    s_mov_b32 s74, 786432
    s_mul_i32 s60, s62, 25165824
    s_add_u32 s60, s60, s61
    s_cmp_lg_u32 s62, 16
    s_cbranch_scc1 L_nb45
    s_mov_b64 s[8:9], s[40:41]
    s_add_u32 s60, s61, 301989888
L_nb45:
    s_cbranch_vccnz L_dp44
    s_waitcnt vmcnt(6)
L_dp44:
    s_waitcnt vmcnt(7)
    buffer_load_dwordx4 v[56:59], v1, s[8:11], s60 offen offset:0 nt
    v_add_f32_dpp v11, v9, v9 row_half_mirror row_mask:0xf bank_mask:0xa
    v_dot2_f32_bf16 v8, v64, v32, 0
    v_dot2_f32_bf16 v8, v65, v33, v8
    v_dot2_f32_bf16 v8, v66, v34, v8
    v_dot2_f32_bf16 v8, v67, v35, v8
    s_cbranch_vccnz L_dp46
    s_waitcnt vmcnt(6)
L_dp46:
    s_waitcnt vmcnt(7)
    buffer_load_dwordx4 v[60:63], v1, s[8:11], s60 offen offset:128 nt
    v_add_f32_dpp v11, v11, v11 quad_perm:[2,3,0,1] row_mask:0xf bank_mask:0xf
    v_dot2_f32_bf16 v8, v68, v36, v8
    v_dot2_f32_bf16 v8, v69, v37, v8
    v_dot2_f32_bf16 v8, v70, v38, v8
    v_dot2_f32_bf16 v8, v71, v39, v8
    s_cbranch_vccnz L_dp47
    s_waitcnt vmcnt(6)
L_dp47:
    s_waitcnt vmcnt(7)
    buffer_load_dwordx4 v[64:67], v1, s[8:11], s60 offen offset:256 nt
    s_add_u32 s63, s63, 1
    s_lshr_b32 s67, s63, 1
    s_cmp_eq_u32 s63, s83
    s_cselect_b32 s67, 8, s67
    s_mul_i32 s67, s67, 384
    v_add_u32 v51, s67, v4
    v_dot2_f32_bf16 v8, v72, v40, v8
    v_dot2_f32_bf16 v8, v73, v41, v8
    v_dot2_f32_bf16 v8, v74, v42, v8
    v_dot2_f32_bf16 v8, v75, v43, v8
    s_add_u32 s60, s60, s74
    s_cbranch_vccnz L_dp48
    s_waitcnt vmcnt(6)
L_dp48:
    s_waitcnt vmcnt(7)
    buffer_load_dwordx4 v[68:71], v1, s[8:11], s60 offen offset:0 nt
    v_add_f32_dpp v12, v8, v8 row_half_mirror row_mask:0xf bank_mask:0xa
    v_dot2_f32_bf16 v9, v76, v32, 0
    v_dot2_f32_bf16 v9, v77, v33, v9
    v_dot2_f32_bf16 v9, v78, v34, v9
    v_dot2_f32_bf16 v9, v79, v35, v9
    ds_read_b128 v[32:35], v51 offset:0
    s_cbranch_vccnz L_dp49
    s_waitcnt vmcnt(4)
L_dp49:
    s_waitcnt vmcnt(7)
    buffer_load_dwordx4 v[72:75], v1, s[8:11], s60 offen offset:128 nt
    v_add_f32_dpp v12, v12, v12 quad_perm:[2,3,0,1] row_mask:0xf bank_mask:0xf
    v_dot2_f32_bf16 v9, v80, v36, v9
    v_dot2_f32_bf16 v9, v81, v37, v9
    v_dot2_f32_bf16 v9, v82, v38, v9
    v_dot2_f32_bf16 v9, v83, v39, v9
    ds_read_b128 v[36:39], v51 offset:128
    s_cbranch_vccnz L_dp50
    s_waitcnt vmcnt(4)
L_dp50:
    s_waitcnt vmcnt(5)
    buffer_load_dwordx4 v[76:79], v1, s[8:11], s60 offen offset:256 nt
    v_readlane_b32 s68, v53, 32
    s_nop 0
    s_sub_u32 s68, s68, s46
    s_cmp_lt_u32 s68, 33
    s_cselect_b32 s72, s68, s72
    v_sub_u32 v53, v53, v52
    v_cmp_gt_u32 vcc, 64, v53
    s_nop 0
    s_bcnt1_i32_b32 s67, vcc_lo
    s_cmp_gt_u32 s67, s72
    s_cselect_b64 vcc, -1, 0
    v_cndmask_b32 v14, v10, v12, s[12:13]
    v_dot2_f32_bf16 v9, v84, v40, v9
    v_dot2_f32_bf16 v9, v85, v41, v9
    v_dot2_f32_bf16 v9, v86, v42, v9
    v_dot2_f32_bf16 v9, v87, v43, v9
    v_add_f32_dpp v14, v14, v14 quad_perm:[1,0,3,2] row_mask:0xf bank_mask:0xf
    ds_read_b128 v[40:43], v51 offset:256
    s_cmp_lt_u32 s63, 16
    s_cbranch_scc1 L_k
    v_add_f32_dpp v13, v9, v9 row_half_mirror row_mask:0xf bank_mask:0xa
    s_nop 1
    v_add_f32_dpp v13, v13, v13 quad_perm:[2,3,0,1] row_mask:0xf bank_mask:0xf
    v_cndmask_b32 v15, v11, v13, s[12:13]
    s_nop 1
    v_add_f32_dpp v15, v15, v15 quad_perm:[1,0,3,2] row_mask:0xf bank_mask:0xf
    v_cndmask_b32 v14, v14, v15, s[14:15]
    ds_write_b32 v5, v14
    v_add_u32 v5, 256, v5
    v_subrev_u32 v5, 4096, v5
    ds_read_b32 v45, v5 offset:3072
    s_lshl_b32 s67, s3, 10
    s_add_u32 s67, s67, 0
    v_add_u32 v4, s67, v7
    s_mov_b32 s73, 0
    s_waitcnt lgkmcnt(0)
    v_mov_b32 v8, 0
    v_mov_b32 v9, 0
    v_mov_b32 v10, 0
    v_mov_b32 v11, 0
    v_mov_b32 v12, 0
    v_mov_b32 v13, 0
    v_mov_b32 v14, 0
    v_mov_b32 v15, 0
    v_mov_b32 v16, 0
    v_mov_b32 v17, 0
    v_mov_b32 v18, 0
    v_mov_b32 v19, 0
    v_mov_b32 v20, 0
    v_mov_b32 v21, 0
    v_mov_b32 v22, 0
    v_mov_b32 v23, 0
    v_mov_b32 v24, 0
    v_mov_b32 v25, 0
    v_mov_b32 v26, 0
    v_mov_b32 v27, 0
    v_mov_b32 v28, 0
    v_mov_b32 v29, 0
    v_mov_b32 v30, 0
    v_mov_b32 v31, 0
L_v:
    s_add_u32 s60, s60, s74
    s_cbranch_vccnz L_dp51
    s_waitcnt vmcnt(4)
L_dp51:
    s_waitcnt vmcnt(5)
    buffer_load_dwordx4 v[80:83], v1, s[8:11], s60 offen offset:0 nt
    v_add_u32 v52, 1, v52
    buffer_store_dword v52, v55, s[28:31], 0 offen
    buffer_load_dword v53, v54, s[28:31], 0 offen nt
    s_waitcnt lgkmcnt(0)
    v_mov_b32 v44, v45
    s_cmp_eq_u32 s73, 0
    s_cbranch_scc1 L_c0
    v_permlane32_swap_b32 v24, v28
    v_permlane32_swap_b32 v25, v29
    v_permlane32_swap_b32 v26, v30
    v_permlane32_swap_b32 v27, v31
    v_add_f32 v40, v24, v28
    v_add_f32 v41, v25, v29
    v_add_f32 v42, v26, v30
    v_add_f32 v43, v27, v31
    v_mov_b32 v24, 0
    v_mov_b32 v25, 0
    v_mov_b32 v26, 0
    v_mov_b32 v27, 0
    v_mov_b32 v28, 0
    v_mov_b32 v29, 0
    v_mov_b32 v30, 0
    v_mov_b32 v31, 0
L_c0:
    v_mov_b32_dpp v46, v44 row_newbcast:0 row_mask:0xf bank_mask:0x3
    s_nop 1
    v_mov_b32_dpp v46, v44 row_newbcast:8 row_mask:0xf bank_mask:0xc
    v_lshlrev_b32 v47, 16, v46
    v_dot2c_f32_bf16 v8, v56, v46
    v_dot2c_f32_bf16 v9, v56, v47
    v_dot2c_f32_bf16 v10, v57, v46
    v_dot2c_f32_bf16 v11, v57, v47
    v_dot2c_f32_bf16 v12, v58, v46
    v_dot2c_f32_bf16 v13, v58, v47
    v_dot2c_f32_bf16 v14, v59, v46
    v_dot2c_f32_bf16 v15, v59, v47
    s_cbranch_vccnz L_dp52
    s_waitcnt vmcnt(6)
L_dp52:
    s_waitcnt vmcnt(7)
    buffer_load_dwordx4 v[84:87], v1, s[8:11], s60 offen offset:128 nt
    s_cmp_eq_u32 s73, 0
    s_cbranch_scc1 L_c1
    v_permlane16_swap_b32 v40, v42
    v_permlane16_swap_b32 v41, v43
    v_add_f32 v40, v40, v42
    v_add_f32 v41, v41, v43
    s_nop 0
    v_add_f32_dpp v50, v40, v40 row_ror:8 row_mask:0xf bank_mask:0x3
    s_nop 1
    v_add_f32_dpp v50, v41, v41 row_ror:8 row_mask:0xf bank_mask:0xc
    ds_write_b96 v4, v[48:50]
    v_xor_b32 v4, 4096, v4
L_c1:
    v_dot2c_f32_bf16 v16, v60, v46
    v_dot2c_f32_bf16 v17, v60, v47
    v_dot2c_f32_bf16 v18, v61, v46
    v_dot2c_f32_bf16 v19, v61, v47
    v_dot2c_f32_bf16 v20, v62, v46
    v_dot2c_f32_bf16 v21, v62, v47
    v_dot2c_f32_bf16 v22, v63, v46
    v_dot2c_f32_bf16 v23, v63, v47
    s_cbranch_vccnz L_dp53
    s_waitcnt vmcnt(6)
L_dp53:
    s_waitcnt vmcnt(7)
    buffer_load_dwordx4 v[56:59], v1, s[8:11], s60 offen offset:256 nt
    s_waitcnt lgkmcnt(0)
    s_barrier
    v_dot2c_f32_bf16 v24, v64, v46
    v_dot2c_f32_bf16 v25, v64, v47
    v_dot2c_f32_bf16 v26, v65, v46
    v_dot2c_f32_bf16 v27, v65, v47
    v_dot2c_f32_bf16 v28, v66, v46
    v_dot2c_f32_bf16 v29, v66, v47
    v_dot2c_f32_bf16 v30, v67, v46
    v_dot2c_f32_bf16 v31, v67, v47
    s_add_u32 s60, s60, s74
    s_cbranch_vccnz L_dp54
    s_waitcnt vmcnt(6)
L_dp54:
    s_waitcnt vmcnt(7)
    buffer_load_dwordx4 v[60:63], v1, s[8:11], s60 offen offset:0 nt
    v_mov_b32_dpp v46, v44 row_newbcast:1 row_mask:0xf bank_mask:0x3
    s_nop 1
    v_mov_b32_dpp v46, v44 row_newbcast:9 row_mask:0xf bank_mask:0xc
    v_lshlrev_b32 v47, 16, v46
    v_dot2c_f32_bf16 v8, v68, v46
    v_dot2c_f32_bf16 v9, v68, v47
    v_dot2c_f32_bf16 v10, v69, v46
    v_dot2c_f32_bf16 v11, v69, v47
    v_dot2c_f32_bf16 v12, v70, v46
    v_dot2c_f32_bf16 v13, v70, v47
    v_dot2c_f32_bf16 v14, v71, v46
    v_dot2c_f32_bf16 v15, v71, v47
    s_cbranch_vccnz L_dp55
    s_waitcnt vmcnt(6)
L_dp55:
    s_waitcnt vmcnt(7)
    buffer_load_dwordx4 v[64:67], v1, s[8:11], s60 offen offset:128 nt
    v_dot2c_f32_bf16 v16, v72, v46
    v_dot2c_f32_bf16 v17, v72, v47
    v_dot2c_f32_bf16 v18, v73, v46
    v_dot2c_f32_bf16 v19, v73, v47
    v_dot2c_f32_bf16 v20, v74, v46
    v_dot2c_f32_bf16 v21, v74, v47
    v_dot2c_f32_bf16 v22, v75, v46
    v_dot2c_f32_bf16 v23, v75, v47
    s_cbranch_vccnz L_dp56
    s_waitcnt vmcnt(6)
L_dp56:
    s_waitcnt vmcnt(7)
    buffer_load_dwordx4 v[68:71], v1, s[8:11], s60 offen offset:256 nt
    v_dot2c_f32_bf16 v24, v76, v46
    v_dot2c_f32_bf16 v25, v76, v47
    v_dot2c_f32_bf16 v26, v77, v46
    v_dot2c_f32_bf16 v27, v77, v47
    v_dot2c_f32_bf16 v28, v78, v46
    v_dot2c_f32_bf16 v29, v78, v47
    v_dot2c_f32_bf16 v30, v79, v46
    v_dot2c_f32_bf16 v31, v79, v47
    s_add_u32 s60, s60, s74
    s_cbranch_vccnz L_dp57
    s_waitcnt vmcnt(4)
L_dp57:
    s_waitcnt vmcnt(7)
    buffer_load_dwordx4 v[72:75], v1, s[8:11], s60 offen offset:0 nt
    v_mov_b32_dpp v46, v44 row_newbcast:2 row_mask:0xf bank_mask:0x3
    s_nop 1
    v_mov_b32_dpp v46, v44 row_newbcast:10 row_mask:0xf bank_mask:0xc
    v_lshlrev_b32 v47, 16, v46
    v_dot2c_f32_bf16 v8, v80, v46
    v_dot2c_f32_bf16 v9, v80, v47
    v_dot2c_f32_bf16 v10, v81, v46
    v_dot2c_f32_bf16 v11, v81, v47
    v_dot2c_f32_bf16 v12, v82, v46
    v_dot2c_f32_bf16 v13, v82, v47
    v_dot2c_f32_bf16 v14, v83, v46
    v_dot2c_f32_bf16 v15, v83, v47
    s_cbranch_vccnz L_dp58
    s_waitcnt vmcnt(4)
L_dp58:
    s_waitcnt vmcnt(5)
    buffer_load_dwordx4 v[76:79], v1, s[8:11], s60 offen offset:128 nt
    v_readlane_b32 s68, v53, 32
    s_nop 0
    s_sub_u32 s68, s68, s46
    s_cmp_lt_u32 s68, 33
    s_cselect_b32 s72, s68, s72
    v_sub_u32 v53, v53, v52
    v_cmp_gt_u32 vcc, 64, v53
    s_nop 0
    s_bcnt1_i32_b32 s67, vcc_lo
    s_cmp_gt_u32 s67, s72
    s_cselect_b64 vcc, -1, 0
    v_dot2c_f32_bf16 v16, v84, v46
    v_dot2c_f32_bf16 v17, v84, v47
    v_dot2c_f32_bf16 v18, v85, v46
    v_dot2c_f32_bf16 v19, v85, v47
    v_dot2c_f32_bf16 v20, v86, v46
    v_dot2c_f32_bf16 v21, v86, v47
    v_dot2c_f32_bf16 v22, v87, v46
    v_dot2c_f32_bf16 v23, v87, v47
    s_cbranch_vccnz L_dp59
    s_waitcnt vmcnt(4)
L_dp59:
    s_waitcnt vmcnt(5)
    buffer_load_dwordx4 v[80:83], v1, s[8:11], s60 offen offset:256 nt
    v_add_u32 v52, 1, v52
    buffer_store_dword v52, v55, s[28:31], 0 offen
    buffer_load_dword v53, v54, s[28:31], 0 offen nt
    v_dot2c_f32_bf16 v24, v56, v46
    v_dot2c_f32_bf16 v25, v56, v47
    v_dot2c_f32_bf16 v26, v57, v46
    v_dot2c_f32_bf16 v27, v57, v47
    v_dot2c_f32_bf16 v28, v58, v46
    v_dot2c_f32_bf16 v29, v58, v47
    v_dot2c_f32_bf16 v30, v59, v46
    v_dot2c_f32_bf16 v31, v59, v47
    s_add_u32 s60, s60, s74
    s_cbranch_vccnz L_dp60
    s_waitcnt vmcnt(6)
L_dp60:
    s_waitcnt vmcnt(7)
    buffer_load_dwordx4 v[84:87], v1, s[8:11], s60 offen offset:0 nt
    v_mov_b32_dpp v46, v44 row_newbcast:3 row_mask:0xf bank_mask:0x3
    s_nop 1
    v_mov_b32_dpp v46, v44 row_newbcast:11 row_mask:0xf bank_mask:0xc
    v_lshlrev_b32 v47, 16, v46
    v_dot2c_f32_bf16 v8, v60, v46
    v_dot2c_f32_bf16 v9, v60, v47
    v_dot2c_f32_bf16 v10, v61, v46
    v_dot2c_f32_bf16 v11, v61, v47
    v_dot2c_f32_bf16 v12, v62, v46
    v_dot2c_f32_bf16 v13, v62, v47
    v_dot2c_f32_bf16 v14, v63, v46
    v_dot2c_f32_bf16 v15, v63, v47
    s_cbranch_vccnz L_dp61
    s_waitcnt vmcnt(6)
L_dp61:
    s_waitcnt vmcnt(7)
    buffer_load_dwordx4 v[56:59], v1, s[8:11], s60 offen offset:128 nt
    v_dot2c_f32_bf16 v16, v64, v46
    v_dot2c_f32_bf16 v17, v64, v47
    v_dot2c_f32_bf16 v18, v65, v46
    v_dot2c_f32_bf16 v19, v65, v47
    v_dot2c_f32_bf16 v20, v66, v46
    v_dot2c_f32_bf16 v21, v66, v47
    v_dot2c_f32_bf16 v22, v67, v46
    v_dot2c_f32_bf16 v23, v67, v47
    s_cbranch_vccnz L_dp62
    s_waitcnt vmcnt(6)
L_dp62:
    s_waitcnt vmcnt(7)
    buffer_load_dwordx4 v[60:63], v1, s[8:11], s60 offen offset:256 nt
    v_dot2c_f32_bf16 v24, v68, v46
    v_dot2c_f32_bf16 v25, v68, v47
    v_dot2c_f32_bf16 v26, v69, v46
    v_dot2c_f32_bf16 v27, v69, v47
    v_dot2c_f32_bf16 v28, v70, v46
    v_dot2c_f32_bf16 v29, v70, v47
    v_dot2c_f32_bf16 v30, v71, v46
    v_dot2c_f32_bf16 v31, v71, v47
    s_add_u32 s60, s60, s74
    s_cbranch_vccnz L_dp63
    s_waitcnt vmcnt(6)
L_dp63:
    s_waitcnt vmcnt(7)
    buffer_load_dwordx4 v[64:67], v1, s[8:11], s60 offen offset:0 nt
    v_mov_b32_dpp v46, v44 row_newbcast:4 row_mask:0xf bank_mask:0x3
    s_nop 1
    v_mov_b32_dpp v46, v44 row_newbcast:12 row_mask:0xf bank_mask:0xc
    v_lshlrev_b32 v47, 16, v46
    v_dot2c_f32_bf16 v8, v72, v46
    v_dot2c_f32_bf16 v9, v72, v47
    v_dot2c_f32_bf16 v10, v73, v46
    v_dot2c_f32_bf16 v11, v73, v47
    v_dot2c_f32_bf16 v12, v74, v46
    v_dot2c_f32_bf16 v13, v74, v47
    v_dot2c_f32_bf16 v14, v75, v46
    v_dot2c_f32_bf16 v15, v75, v47
    s_cbranch_vccnz L_dp64
    s_waitcnt vmcnt(6)
L_dp64:
    s_waitcnt vmcnt(7)
    buffer_load_dwordx4 v[68:71], v1, s[8:11], s60 offen offset:128 nt
    v_dot2c_f32_bf16 v16, v76, v46
    v_dot2c_f32_bf16 v17, v76, v47
    v_dot2c_f32_bf16 v18, v77, v46
    v_dot2c_f32_bf16 v19, v77, v47
    v_dot2c_f32_bf16 v20, v78, v46
    v_dot2c_f32_bf16 v21, v78, v47
    v_dot2c_f32_bf16 v22, v79, v46
    v_dot2c_f32_bf16 v23, v79, v47
    s_cbranch_vccnz L_dp65
    s_waitcnt vmcnt(4)
L_dp65:
    s_waitcnt vmcnt(7)
    buffer_load_dwordx4 v[72:75], v1, s[8:11], s60 offen offset:256 nt
    v_dot2c_f32_bf16 v24, v80, v46
    v_dot2c_f32_bf16 v25, v80, v47
    v_dot2c_f32_bf16 v26, v81, v46
    v_dot2c_f32_bf16 v27, v81, v47
    v_dot2c_f32_bf16 v28, v82, v46
    v_dot2c_f32_bf16 v29, v82, v47
    v_dot2c_f32_bf16 v30, v83, v46
    v_dot2c_f32_bf16 v31, v83, v47
    s_add_u32 s60, s60, s74
    s_cbranch_vccnz L_dp66
    s_waitcnt vmcnt(4)
L_dp66:
    s_waitcnt vmcnt(5)
    buffer_load_dwordx4 v[76:79], v1, s[8:11], s60 offen offset:0 nt
    v_readlane_b32 s68, v53, 32
    s_nop 0
    s_sub_u32 s68, s68, s46
    s_cmp_lt_u32 s68, 33
    s_cselect_b32 s72, s68, s72
    v_sub_u32 v53, v53, v52
    v_cmp_gt_u32 vcc, 64, v53
    s_nop 0
    s_bcnt1_i32_b32 s67, vcc_lo
    s_cmp_gt_u32 s67, s72
    s_cselect_b64 vcc, -1, 0
    v_mov_b32_dpp v46, v44 row_newbcast:5 row_mask:0xf bank_mask:0x3
    s_nop 1
    v_mov_b32_dpp v46, v44 row_newbcast:13 row_mask:0xf bank_mask:0xc
    v_lshlrev_b32 v47, 16, v46
    v_dot2c_f32_bf16 v8, v84, v46
    v_dot2c_f32_bf16 v9, v84, v47
    v_dot2c_f32_bf16 v10, v85, v46
    v_dot2c_f32_bf16 v11, v85, v47
    v_dot2c_f32_bf16 v12, v86, v46
    v_dot2c_f32_bf16 v13, v86, v47
    v_dot2c_f32_bf16 v14, v87, v46
    v_dot2c_f32_bf16 v15, v87, v47
    s_cbranch_vccnz L_dp67
    s_waitcnt vmcnt(4)
L_dp67:
    s_waitcnt vmcnt(5)
    buffer_load_dwordx4 v[80:83], v1, s[8:11], s60 offen offset:128 nt
    v_add_u32 v52, 1, v52
    buffer_store_dword v52, v55, s[28:31], 0 offen
    buffer_load_dword v53, v54, s[28:31], 0 offen nt
    v_dot2c_f32_bf16 v16, v56, v46
    v_dot2c_f32_bf16 v17, v56, v47
    v_dot2c_f32_bf16 v18, v57, v46
    v_dot2c_f32_bf16 v19, v57, v47
    v_dot2c_f32_bf16 v20, v58, v46
    v_dot2c_f32_bf16 v21, v58, v47
    v_dot2c_f32_bf16 v22, v59, v46
    v_dot2c_f32_bf16 v23, v59, v47
    s_cbranch_vccnz L_dp68
    s_waitcnt vmcnt(6)
L_dp68:
    s_waitcnt vmcnt(7)
    buffer_load_dwordx4 v[84:87], v1, s[8:11], s60 offen offset:256 nt
    v_dot2c_f32_bf16 v24, v60, v46
    v_dot2c_f32_bf16 v25, v60, v47
    v_dot2c_f32_bf16 v26, v61, v46
    v_dot2c_f32_bf16 v27, v61, v47
    v_dot2c_f32_bf16 v28, v62, v46
    v_dot2c_f32_bf16 v29, v62, v47
    v_dot2c_f32_bf16 v30, v63, v46
    v_dot2c_f32_bf16 v31, v63, v47
    s_cmp_eq_u32 s63, 31
    s_cbranch_scc1 L_vend
    s_add_u32 s60, s60, s74
    s_add_u32 s62, s62, 1
    s_sub_u32 s67, s62, 20
    s_cmp_gt_u32 s67, 1
    s_cbranch_scc1 L_n570
    s_add_u32 s60, s75, 25165824
    s_mov_b32 s74, 1572864
    s_cmp_eq_u32 s67, 0
    s_cbranch_scc1 L_nb70
    s_add_u32 s60, s75, 11010048
    s_mov_b32 s74, -1572864
    s_branch L_nb70
L_n570:
    s_and_b32 s67, s62, 1
    s_cbranch_scc1 L_nb70
    s_mov_b32 s74, 786432
    s_lshl_b32 s67, s62, 1
    s_lshr_b32 s67, 0x1234576, s67
    s_and_b32 s67, s67, 7
    s_mul_i32 s60, s67, 50331648
    s_add_u32 s60, s60, s61
L_nb70:
    s_cbranch_vccnz L_dp69
    s_waitcnt vmcnt(6)
L_dp69:
    s_waitcnt vmcnt(7)
    buffer_load_dwordx4 v[56:59], v1, s[8:11], s60 offen offset:0 nt
    v_mov_b32_dpp v46, v44 row_newbcast:6 row_mask:0xf bank_mask:0x3
    s_nop 1
    v_mov_b32_dpp v46, v44 row_newbcast:14 row_mask:0xf bank_mask:0xc
    v_lshlrev_b32 v47, 16, v46
    v_dot2c_f32_bf16 v8, v64, v46
    v_dot2c_f32_bf16 v9, v64, v47
    v_dot2c_f32_bf16 v10, v65, v46
    v_dot2c_f32_bf16 v11, v65, v47
    v_dot2c_f32_bf16 v12, v66, v46
    v_dot2c_f32_bf16 v13, v66, v47
    v_dot2c_f32_bf16 v14, v67, v46
    v_dot2c_f32_bf16 v15, v67, v47
    s_cbranch_vccnz L_dp71
    s_waitcnt vmcnt(6)
L_dp71:
    s_waitcnt vmcnt(7)
    buffer_load_dwordx4 v[60:63], v1, s[8:11], s60 offen offset:128 nt
    v_dot2c_f32_bf16 v16, v68, v46
    v_dot2c_f32_bf16 v17, v68, v47
    v_dot2c_f32_bf16 v18, v69, v46
    v_dot2c_f32_bf16 v19, v69, v47
    v_dot2c_f32_bf16 v20, v70, v46
    v_dot2c_f32_bf16 v21, v70, v47
    v_dot2c_f32_bf16 v22, v71, v46
    v_dot2c_f32_bf16 v23, v71, v47
    s_cbranch_vccnz L_dp72
    s_waitcnt vmcnt(6)
L_dp72:
    s_waitcnt vmcnt(7)
    buffer_load_dwordx4 v[64:67], v1, s[8:11], s60 offen offset:256 nt
    s_add_u32 s68, s63, 1
    s_bitcmp1_b32 0x55740001, s68
    s_cselect_b32 s73, 1, 0
    s_and_b32 s67, s68, 1
    s_and_b32 s68, s68, 14
    s_lshl_b32 s68, s68, 1
    s_lshr_b32 s68, 0x1234576, s68
    s_and_b32 s68, s68, 7
    s_cmp_eq_u32 s68, 5
    s_cselect_b32 s69, 1, 0
    s_xor_b32 s67, s67, s69
    s_lshl_b32 s68, s68, 1
    s_add_u32 s68, s68, s67
    s_lshl_b32 s68, s68, 8
    v_add_u32 v51, s68, v5
    ds_read_b32 v45, v51
    v_dot2c_f32_bf16 v24, v72, v46
    v_dot2c_f32_bf16 v25, v72, v47
    v_dot2c_f32_bf16 v26, v73, v46
    v_dot2c_f32_bf16 v27, v73, v47
    v_dot2c_f32_bf16 v28, v74, v46
    v_dot2c_f32_bf16 v29, v74, v47
    v_dot2c_f32_bf16 v30, v75, v46
    v_dot2c_f32_bf16 v31, v75, v47
    s_add_u32 s60, s60, s74
    s_cbranch_vccnz L_dp73
    s_waitcnt vmcnt(6)
L_dp73:
    s_waitcnt vmcnt(7)
    buffer_load_dwordx4 v[68:71], v1, s[8:11], s60 offen offset:0 nt
    v_mov_b32_dpp v46, v44 row_newbcast:7 row_mask:0xf bank_mask:0x3
    s_nop 1
    v_mov_b32_dpp v46, v44 row_newbcast:15 row_mask:0xf bank_mask:0xc
    v_lshlrev_b32 v47, 16, v46
    v_dot2c_f32_bf16 v8, v76, v46
    v_dot2c_f32_bf16 v9, v76, v47
    v_dot2c_f32_bf16 v10, v77, v46
    v_dot2c_f32_bf16 v11, v77, v47
    v_dot2c_f32_bf16 v12, v78, v46
    v_dot2c_f32_bf16 v13, v78, v47
    v_dot2c_f32_bf16 v14, v79, v46
    v_dot2c_f32_bf16 v15, v79, v47
    s_cmp_eq_u32 s73, 0
    s_cbranch_scc1 L_c21
    v_permlane32_swap_b32 v8, v12
    v_permlane32_swap_b32 v9, v13
    v_permlane32_swap_b32 v10, v14
    v_permlane32_swap_b32 v11, v15
    v_add_f32 v32, v8, v12
    v_add_f32 v33, v9, v13
    v_add_f32 v34, v10, v14
    v_add_f32 v35, v11, v15
    v_mov_b32 v8, 0
    v_mov_b32 v9, 0
    v_mov_b32 v10, 0
    v_mov_b32 v11, 0
    v_mov_b32 v12, 0
    v_mov_b32 v13, 0
    v_mov_b32 v14, 0
    v_mov_b32 v15, 0
    v_permlane16_swap_b32 v32, v34
    v_permlane16_swap_b32 v33, v35
    v_add_f32 v32, v32, v34
    v_add_f32 v33, v33, v35
    s_nop 0
    v_add_f32_dpp v48, v32, v32 row_ror:8 row_mask:0xf bank_mask:0x3
    s_nop 1
    v_add_f32_dpp v48, v33, v33 row_ror:8 row_mask:0xf bank_mask:0xc
L_c21:
    s_cbranch_vccnz L_dp74
    s_waitcnt vmcnt(4)
L_dp74:
    s_waitcnt vmcnt(7)
    buffer_load_dwordx4 v[72:75], v1, s[8:11], s60 offen offset:128 nt
    v_dot2c_f32_bf16 v16, v80, v46
    v_dot2c_f32_bf16 v17, v80, v47
    v_dot2c_f32_bf16 v18, v81, v46
    v_dot2c_f32_bf16 v19, v81, v47
    v_dot2c_f32_bf16 v20, v82, v46
    v_dot2c_f32_bf16 v21, v82, v47
    v_dot2c_f32_bf16 v22, v83, v46
    v_dot2c_f32_bf16 v23, v83, v47
    s_cmp_eq_u32 s73, 0
    s_cbranch_scc1 L_c22
    v_permlane32_swap_b32 v16, v20
    v_permlane32_swap_b32 v17, v21
    v_permlane32_swap_b32 v18, v22
    v_permlane32_swap_b32 v19, v23
    v_add_f32 v36, v16, v20
    v_add_f32 v37, v17, v21
    v_add_f32 v38, v18, v22
    v_add_f32 v39, v19, v23
    v_mov_b32 v16, 0
    v_mov_b32 v17, 0
    v_mov_b32 v18, 0
    v_mov_b32 v19, 0
    v_mov_b32 v20, 0
    v_mov_b32 v21, 0
    v_mov_b32 v22, 0
    v_mov_b32 v23, 0
    v_permlane16_swap_b32 v36, v38
    v_permlane16_swap_b32 v37, v39
    v_add_f32 v36, v36, v38
    v_add_f32 v37, v37, v39
    s_nop 0
    v_add_f32_dpp v49, v36, v36 row_ror:8 row_mask:0xf bank_mask:0x3
    s_nop 1
    v_add_f32_dpp v49, v37, v37 row_ror:8 row_mask:0xf bank_mask:0xc
L_c22:
    s_cbranch_vccnz L_dp75
    s_waitcnt vmcnt(4)
L_dp75:
    s_waitcnt vmcnt(5)
    buffer_load_dwordx4 v[76:79], v1, s[8:11], s60 offen offset:256 nt
    v_readlane_b32 s68, v53, 32
    s_nop 0
    s_sub_u32 s68, s68, s46
    s_cmp_lt_u32 s68, 33
    s_cselect_b32 s72, s68, s72
    v_sub_u32 v53, v53, v52
    v_cmp_gt_u32 vcc, 64, v53
    s_nop 0
    s_bcnt1_i32_b32 s67, vcc_lo
    s_cmp_gt_u32 s67, s72
    s_cselect_b64 vcc, -1, 0
    v_dot2c_f32_bf16 v24, v84, v46
    v_dot2c_f32_bf16 v25, v84, v47
    v_dot2c_f32_bf16 v26, v85, v46
    v_dot2c_f32_bf16 v27, v85, v47
    v_dot2c_f32_bf16 v28, v86, v46
    v_dot2c_f32_bf16 v29, v86, v47
    v_dot2c_f32_bf16 v30, v87, v46
    v_dot2c_f32_bf16 v31, v87, v47
    s_add_u32 s63, s63, 1
    s_branch L_v
L_vend:
    s_mov_b32 s68, 2621440
    s_cmp_eq_u32 s3, 0
    s_cselect_b32 s68, 1049600, s68
    s_cmp_eq_u32 s3, 1
    s_cselect_b32 s68, 525312, s68
    s_cmp_eq_u32 s3, 2
    s_cselect_b32 s68, 524288, s68
    s_lshl_b32 s67, s64, 11
    s_add_u32 s68, s68, s67
    s_lshl_b32 s67, s3, 4
    v_mov_b32 v194, s67
    s_waitcnt vmcnt(7)
    buffer_load_dwordx4 v[104:107], v7, s[20:23], s80 offen offset:0 nt
    buffer_load_dword v128, v54, s[20:23], s80 offen offset:1024 nt
    buffer_load_dwordx4 v[108:111], v7, s[20:23], s80 offen offset:1280 nt
    buffer_load_dword v129, v54, s[20:23], s80 offen offset:2304 nt
    v_mov_b32_dpp v46, v44 row_newbcast:6 row_mask:0xf bank_mask:0x3
    s_nop 1
    v_mov_b32_dpp v46, v44 row_newbcast:14 row_mask:0xf bank_mask:0xc
    v_lshlrev_b32 v47, 16, v46
    v_dot2c_f32_bf16 v8, v64, v46
    v_dot2c_f32_bf16 v9, v64, v47
    v_dot2c_f32_bf16 v10, v65, v46
    v_dot2c_f32_bf16 v11, v65, v47
    v_dot2c_f32_bf16 v12, v66, v46
    v_dot2c_f32_bf16 v13, v66, v47
    v_dot2c_f32_bf16 v14, v67, v46
    v_dot2c_f32_bf16 v15, v67, v47
    s_mul_i32 s67, s3, 640
    v_mul_u32_u24 v190, 80, v2
    v_mad_u32_u24 v190, v3, 12, v190
    v_add_u32 v190, s67, v190
    v_lshrrev_b32 v191, 1, v190
    ds_read_u16 v170, v191 offset:15872
    ds_read_u16 v171, v191 offset:15874
    ds_read_u16 v172, v191 offset:15876
    ds_read_u16 v173, v191 offset:17152
    ds_read_u16 v174, v191 offset:17154
    ds_read_u16 v175, v191 offset:17156
    ds_read_u16 v176, v191 offset:18432
    ds_read_u16 v177, v191 offset:18434
    ds_read_u16 v178, v191 offset:18436
    ds_read_u16 v179, v191 offset:19712
    ds_read_u16 v180, v191 offset:19714
    ds_read_u16 v181, v191 offset:19716
    s_waitcnt vmcnt(10)
    buffer_load_dwordx4 v[112:115], v7, s[20:23], s81 offen offset:0 nt
    buffer_load_dword v130, v54, s[20:23], s81 offen offset:1024 nt
    buffer_load_dword v134, v7, s[16:19], s68 offen sc1
    v_dot2c_f32_bf16 v16, v68, v46
    v_dot2c_f32_bf16 v17, v68, v47
    v_dot2c_f32_bf16 v18, v69, v46
    v_dot2c_f32_bf16 v19, v69, v47
    v_dot2c_f32_bf16 v20, v70, v46
    v_dot2c_f32_bf16 v21, v70, v47
    v_dot2c_f32_bf16 v22, v71, v46
    v_dot2c_f32_bf16 v23, v71, v47
    s_waitcnt lgkmcnt(0)
    ds_read_u16 v182, v191 offset:20992
    ds_read_u16 v183, v191 offset:20994
    ds_read_u16 v184, v191 offset:20996
    ds_read_u16 v185, v191 offset:22272
    ds_read_u16 v186, v191 offset:22274
    ds_read_u16 v187, v191 offset:22276
    s_mul_i32 s67, s3, 2560
    v_lshl_add_u32 v188, v0, 5, s67
    v_lshl_add_u32 v189, v0, 3, s67
    v_add_u32 v190, 23552, v190
    v_mov_b32 v192, 0
    v_mov_b32 v193, 0x10000
    v_mov_b32 v136, 0
    v_mov_b32 v137, 0
    v_mov_b32 v138, 0
    v_mov_b32 v139, 0
    v_mov_b32 v140, 0
    v_mov_b32 v141, 0
    v_mov_b32 v142, 0
    v_mov_b32 v143, 0
    v_mov_b32 v144, 0
    v_mov_b32 v145, 0
    s_waitcnt vmcnt(12)
    buffer_load_dwordx4 v[116:119], v7, s[20:23], s81 offen offset:1280 nt
    buffer_load_dword v131, v54, s[20:23], s81 offen offset:2304 nt
    buffer_load_dwordx4 v[120:123], v7, s[20:23], s82 offen offset:0 nt
    v_dot2c_f32_bf16 v24, v72, v46
    v_dot2c_f32_bf16 v25, v72, v47
    v_dot2c_f32_bf16 v26, v73, v46
    v_dot2c_f32_bf16 v27, v73, v47
    v_dot2c_f32_bf16 v28, v74, v46
    v_dot2c_f32_bf16 v29, v74, v47
    v_dot2c_f32_bf16 v30, v75, v46
    v_dot2c_f32_bf16 v31, v75, v47
    s_waitcnt lgkmcnt(0)
    v_lshl_or_b32 v160, v173, 16, v170
    v_lshl_or_b32 v161, v174, 16, v171
    v_lshl_or_b32 v162, v175, 16, v172
    v_lshl_or_b32 v163, v179, 16, v176
    v_lshl_or_b32 v164, v180, 16, v177
    v_lshl_or_b32 v165, v181, 16, v178
    v_lshl_or_b32 v166, v185, 16, v182
    v_lshl_or_b32 v167, v186, 16, v183
    v_lshl_or_b32 v168, v187, 16, v184
    s_waitcnt vmcnt(14)
    buffer_load_dword v132, v54, s[20:23], s82 offen offset:1024 nt
    buffer_load_dwordx4 v[124:127], v7, s[20:23], s82 offen offset:1280 nt
    buffer_load_dword v133, v54, s[20:23], s82 offen offset:2304 nt
    v_mov_b32_dpp v46, v44 row_newbcast:7 row_mask:0xf bank_mask:0x3
    s_nop 1
    v_mov_b32_dpp v46, v44 row_newbcast:15 row_mask:0xf bank_mask:0xc
    v_lshlrev_b32 v47, 16, v46
    v_dot2c_f32_bf16 v8, v76, v46
    v_dot2c_f32_bf16 v9, v76, v47
    v_dot2c_f32_bf16 v10, v77, v46
    v_dot2c_f32_bf16 v11, v77, v47
    v_dot2c_f32_bf16 v12, v78, v46
    v_dot2c_f32_bf16 v13, v78, v47
    v_dot2c_f32_bf16 v14, v79, v46
    v_dot2c_f32_bf16 v15, v79, v47
    v_permlane32_swap_b32 v8, v12
    v_permlane32_swap_b32 v9, v13
    v_permlane32_swap_b32 v10, v14
    v_permlane32_swap_b32 v11, v15
    v_add_f32 v32, v8, v12
    v_add_f32 v33, v9, v13
    v_add_f32 v34, v10, v14
    v_add_f32 v35, v11, v15
    s_nop 0
    v_permlane16_swap_b32 v32, v34
    v_permlane16_swap_b32 v33, v35
    v_add_f32 v32, v32, v34
    v_add_f32 v33, v33, v35
    s_nop 0
    v_add_f32_dpp v48, v32, v32 row_ror:8 row_mask:0xf bank_mask:0x3
    s_nop 1
    v_add_f32_dpp v48, v33, v33 row_ror:8 row_mask:0xf bank_mask:0xc
    s_waitcnt vmcnt(16)
    v_dot2c_f32_bf16 v16, v80, v46
    v_dot2c_f32_bf16 v17, v80, v47
    v_dot2c_f32_bf16 v18, v81, v46
    v_dot2c_f32_bf16 v19, v81, v47
    v_dot2c_f32_bf16 v20, v82, v46
    v_dot2c_f32_bf16 v21, v82, v47
    v_dot2c_f32_bf16 v22, v83, v46
    v_dot2c_f32_bf16 v23, v83, v47
    v_permlane32_swap_b32 v16, v20
    v_permlane32_swap_b32 v17, v21
    v_permlane32_swap_b32 v18, v22
    v_permlane32_swap_b32 v19, v23
    v_add_f32 v36, v16, v20
    v_add_f32 v37, v17, v21
    v_add_f32 v38, v18, v22
    v_add_f32 v39, v19, v23
    s_nop 0
    v_permlane16_swap_b32 v36, v38
    v_permlane16_swap_b32 v37, v39
    v_add_f32 v36, v36, v38
    v_add_f32 v37, v37, v39
    s_nop 0
    v_add_f32_dpp v49, v36, v36 row_ror:8 row_mask:0xf bank_mask:0x3
    s_nop 1
    v_add_f32_dpp v49, v37, v37 row_ror:8 row_mask:0xf bank_mask:0xc
    s_waitcnt vmcnt(13)
    v_dot2c_f32_bf16 v24, v84, v46
    v_dot2c_f32_bf16 v25, v84, v47
    v_dot2c_f32_bf16 v26, v85, v46
    v_dot2c_f32_bf16 v27, v85, v47
    v_dot2c_f32_bf16 v28, v86, v46
    v_dot2c_f32_bf16 v29, v86, v47
    v_dot2c_f32_bf16 v30, v87, v46
    v_dot2c_f32_bf16 v31, v87, v47
    v_permlane32_swap_b32 v24, v28
    v_permlane32_swap_b32 v25, v29
    v_permlane32_swap_b32 v26, v30
    v_permlane32_swap_b32 v27, v31
    v_add_f32 v40, v24, v28
    v_add_f32 v41, v25, v29
    v_add_f32 v42, v26, v30
    v_add_f32 v43, v27, v31
    s_nop 0
    v_permlane16_swap_b32 v40, v42
    v_permlane16_swap_b32 v41, v43
    v_add_f32 v40, v40, v42
    v_add_f32 v41, v41, v43
    s_nop 0
    v_add_f32_dpp v50, v40, v40 row_ror:8 row_mask:0xf bank_mask:0x3
    s_nop 1
    v_add_f32_dpp v50, v41, v41 row_ror:8 row_mask:0xf bank_mask:0xc
    ds_write_b96 v4, v[48:50]
    v_xor_b32 v4, 4096, v4
    s_waitcnt lgkmcnt(0)
    s_barrier
    ds_read_b128 v[12:15], v194 offset:36416
    v_mov_b32 v19, s46
    v_add_u32 v19, 32, v19
    s_waitcnt lgkmcnt(0)
    v_and_b32 v148, 0xffff, v12
    v_lshlrev_b32 v149, 16, v12
    v_lshrrev_b32 v150, 16, v12
    v_and_b32 v151, 0xffff0000, v12
    v_and_b32 v152, 0xffff, v13
    v_lshlrev_b32 v153, 16, v13
    v_lshrrev_b32 v154, 16, v13
    v_and_b32 v155, 0xffff0000, v13
    v_and_b32 v156, 0xffff, v14
    v_lshlrev_b32 v157, 16, v14
    v_lshrrev_b32 v158, 16, v14
    v_and_b32 v159, 0xffff0000, v14
    v_readfirstlane_b32 s70, v15
    s_waitcnt vmcnt(11)
    v_dot2c_f32_bf16 v136, v104, v148
    v_dot2c_f32_bf16 v137, v104, v149
    v_dot2c_f32_bf16 v138, v105, v148
    v_dot2c_f32_bf16 v139, v105, v149
    v_dot2c_f32_bf16 v140, v106, v148
    v_dot2c_f32_bf16 v141, v106, v149
    v_dot2c_f32_bf16 v142, v107, v148
    v_dot2c_f32_bf16 v143, v107, v149
    v_dot2c_f32_bf16 v144, v128, v148
    v_dot2c_f32_bf16 v145, v128, v149
    s_waitcnt vmcnt(9)
    v_dot2c_f32_bf16 v136, v108, v150
    v_dot2c_f32_bf16 v137, v108, v151
    v_dot2c_f32_bf16 v138, v109, v150
    v_dot2c_f32_bf16 v139, v109, v151
    v_dot2c_f32_bf16 v140, v110, v150
    v_dot2c_f32_bf16 v141, v110, v151
    v_dot2c_f32_bf16 v142, v111, v150
    v_dot2c_f32_bf16 v143, v111, v151
    v_dot2c_f32_bf16 v144, v129, v150
    v_dot2c_f32_bf16 v145, v129, v151
    s_waitcnt vmcnt(7)
    v_dot2c_f32_bf16 v136, v112, v152
    v_dot2c_f32_bf16 v137, v112, v153
    v_dot2c_f32_bf16 v138, v113, v152
    v_dot2c_f32_bf16 v139, v113, v153
    v_dot2c_f32_bf16 v140, v114, v152
    v_dot2c_f32_bf16 v141, v114, v153
    v_dot2c_f32_bf16 v142, v115, v152
    v_dot2c_f32_bf16 v143, v115, v153
    v_dot2c_f32_bf16 v144, v130, v152
    v_dot2c_f32_bf16 v145, v130, v153
    s_waitcnt vmcnt(4)
    v_dot2c_f32_bf16 v136, v116, v154
    v_dot2c_f32_bf16 v137, v116, v155
    v_dot2c_f32_bf16 v138, v117, v154
    v_dot2c_f32_bf16 v139, v117, v155
    v_dot2c_f32_bf16 v140, v118, v154
    v_dot2c_f32_bf16 v141, v118, v155
    v_dot2c_f32_bf16 v142, v119, v154
    v_dot2c_f32_bf16 v143, v119, v155
    v_dot2c_f32_bf16 v144, v131, v154
    v_dot2c_f32_bf16 v145, v131, v155
    s_waitcnt vmcnt(2)
    v_dot2c_f32_bf16 v136, v120, v156
    v_dot2c_f32_bf16 v137, v120, v157
    v_dot2c_f32_bf16 v138, v121, v156
    v_dot2c_f32_bf16 v139, v121, v157
    v_dot2c_f32_bf16 v140, v122, v156
    v_dot2c_f32_bf16 v141, v122, v157
    v_dot2c_f32_bf16 v142, v123, v156
    v_dot2c_f32_bf16 v143, v123, v157
    v_dot2c_f32_bf16 v144, v132, v156
    v_dot2c_f32_bf16 v145, v132, v157
    s_waitcnt vmcnt(0)
    v_dot2c_f32_bf16 v136, v124, v158
    v_dot2c_f32_bf16 v137, v124, v159
    v_dot2c_f32_bf16 v138, v125, v158
    v_dot2c_f32_bf16 v139, v125, v159
    v_dot2c_f32_bf16 v140, v126, v158
    v_dot2c_f32_bf16 v141, v126, v159
    v_dot2c_f32_bf16 v142, v127, v158
    v_dot2c_f32_bf16 v143, v127, v159
    v_dot2c_f32_bf16 v144, v133, v158
    v_dot2c_f32_bf16 v145, v133, v159
    ds_write_b128 v188, v[136:139] offset:23552
    ds_write_b128 v188, v[140:143] offset:23568
    s_nop 0
    ds_write_b64 v189, v[144:145] offset:25600
    s_mov_b64 exec, 1
    ds_add_u32 v192, v193 offset:46528
    s_mov_b64 exec, -1
L_wy:
    ds_read_b32 v41, v192 offset:46528
    s_waitcnt lgkmcnt(0)
    v_cmp_gt_u32 vcc, 0x40000, v41
    s_cbranch_vccnz L_wy
    ds_read2_b32 v[20:21], v190 offset0:0 offset1:1
    ds_read_b32 v22, v190 offset:8
    v_add_u32 v190, 2560, v190
    ds_read2_b32 v[24:25], v190 offset0:0 offset1:1
    ds_read_b32 v26, v190 offset:8
    v_add_u32 v190, 2560, v190
    ds_read2_b32 v[28:29], v190 offset0:0 offset1:1
    ds_read_b32 v30, v190 offset:8
    v_add_u32 v190, 2560, v190
    ds_read2_b32 v[32:33], v190 offset0:0 offset1:1
    ds_read_b32 v34, v190 offset:8
    v_add_u32 v190, 2560, v190
    ds_read2_b32 v[36:37], v190 offset0:0 offset1:1
    ds_read_b32 v38, v190 offset:8
    s_waitcnt lgkmcnt(0)
    v_add_f32 v20, v20, v24
    v_add_f32 v28, v28, v32
    v_add_f32 v21, v21, v25
    v_add_f32 v29, v29, v33
    v_add_f32 v22, v22, v26
    v_add_f32 v30, v30, v34
    v_add_f32 v20, v20, v36
    v_add_f32 v21, v21, v37
    v_add_f32 v22, v22, v38
    v_add_f32 v16, v20, v28
    v_add_f32 v17, v21, v29
    v_add_f32 v18, v22, v30
    s_barrier
    ds_read_b96 v[12:14], v192 offset:36480
    s_waitcnt lgkmcnt(0)
    v_dot2c_f32_bf16 v16, v12, v160
    v_dot2c_f32_bf16 v17, v12, v161
    v_dot2c_f32_bf16 v18, v12, v162
    v_dot2c_f32_bf16 v16, v13, v163
    v_dot2c_f32_bf16 v17, v13, v164
    v_dot2c_f32_bf16 v18, v13, v165
    v_dot2c_f32_bf16 v16, v14, v166
    v_dot2c_f32_bf16 v17, v14, v167
    v_dot2c_f32_bf16 v18, v14, v168
    s_cmp_eq_u32 s70, 0
    s_cbranch_scc1 L_yr
    s_nop 0
    buffer_store_dwordx4 v[16:19], v7, s[16:19], s68 offen
    s_branch L_done
L_yr:
    s_nop 0
    buffer_store_dwordx4 v[16:19], v7, s[16:19], s68 offen sc1
    s_branch L_done
L_svc:
    v_lshlrev_b32 v4, 2, v0
L_wq:
    ds_read_b32 v6, v5 offset:46528
    s_waitcnt lgkmcnt(0)
    v_and_b32 v6, 7, v6
    v_cmp_gt_u32 vcc, 5, v6
    s_cbranch_vccnz L_wq
    ds_read_b32 v56, v4 offset:36544
    ds_read_b32 v57, v4 offset:36800
    ds_read_b32 v58, v4 offset:37056
    ds_read_b32 v59, v4 offset:37312
    ds_read_b32 v60, v4 offset:37568
    ds_read_b32 v61, v4 offset:37824
    ds_read_b32 v62, v4 offset:38080
    ds_read_b32 v63, v4 offset:38336
    ds_read_b32 v64, v4 offset:38592
    ds_read_b32 v65, v4 offset:38848
    ds_read_b32 v66, v4 offset:39104
    ds_read_b32 v67, v4 offset:39360
    ds_read_b32 v68, v4 offset:39616
    ds_read_b32 v69, v4 offset:39872
    ds_read_b32 v70, v4 offset:40128
    s_waitcnt lgkmcnt(0)
    ds_read_b32 v71, v4 offset:40384
    ds_read_b32 v72, v4 offset:40640
    ds_read_b32 v73, v4 offset:40896
    ds_read_b32 v74, v4 offset:41152
    ds_read_b32 v75, v4 offset:41408
    ds_read_b32 v76, v4 offset:41664
    ds_read_b32 v77, v4 offset:41920
    ds_read_b32 v78, v4 offset:42176
    ds_read_b32 v79, v4 offset:42432
    ds_read_b32 v80, v4 offset:42688
    s_waitcnt lgkmcnt(0)
    v_add_f32 v56, v56, v61
    v_add_f32 v57, v57, v62
    v_add_f32 v58, v58, v63
    v_add_f32 v59, v59, v64
    v_add_f32 v60, v60, v65
    v_add_f32 v56, v56, v66
    v_add_f32 v57, v57, v67
    v_add_f32 v58, v58, v68
    v_add_f32 v59, v59, v69
    v_add_f32 v60, v60, v70
    v_add_f32 v56, v56, v71
    v_add_f32 v57, v57, v72
    v_add_f32 v58, v58, v73
    v_add_f32 v59, v59, v74
    v_add_f32 v60, v60, v75
    v_add_f32 v56, v56, v76
    v_add_f32 v57, v57, v77
    v_add_f32 v58, v58, v78
    v_add_f32 v59, v59, v79
    v_add_f32 v60, v60, v80
    v_lshl_add_u32 v5, v3, 3, v2
    v_lshlrev_b32 v32, 1, v5
    v_lshlrev_b32 v5, 4, v5
    v_mov_b32 v48, v59
    v_mov_b32 v49, v60
    v_mov_b32 v55, s46
    v_mov_b32 v50, s46
    v_mov_b32 v51, s46
    v_mov_b32 v52, v56
    v_mov_b32 v53, v57
    v_mov_b32 v54, v58
    s_lshl_b32 s73, s64, 11
    s_add_u32 s73, s73, 524288
    s_cmp_lt_u32 s7, 16
    s_cbranch_scc1 L_qw
    buffer_store_dwordx4 v[52:55], v7, s[16:19], s73 offen
    s_branch L_qd
L_qw:
    buffer_store_dwordx4 v[52:55], v7, s[16:19], s73 offen sc1
L_qd:
    s_bfe_u32 s76, s66, 196609
    s_lshl_b32 s77, s76, 2
    s_add_u32 s77, s77, s6
    s_mul_i32 s77, s77, 12582912
    s_bitcmp1_b32 s66, 4
    s_cselect_b64 s[74:75], s[40:41], s[38:39]
    s_cselect_b64 s[80:81], s[54:55], s[44:45]
    s_cmp_eq_u32 s66, 31
    s_cselect_b64 s[80:81], s[52:53], s[80:81]
    s_bitcmp1_b32 s66, 4
    s_cselect_b32 s76, 0, s76
    s_and_b32 s76, s76, 3
    s_lshl_b32 s76, s76, 21
    s_add_u32 s80, s80, s76
    s_addc_u32 s81, s81, 0
    s_add_u32 s74, s74, s77
    s_addc_u32 s75, s75, 0
    s_bitcmp1_b32 s66, 0
    s_cbranch_scc1 L_pt1
    s_load_dword s76, s[74:75], 0x0
    s_add_u32 s74, s74, 2097152
    s_addc_u32 s75, s75, 0
    s_load_dword s77, s[74:75], 0x0
    s_add_u32 s74, s74, 2097152
    s_addc_u32 s75, s75, 0
    s_load_dword s78, s[74:75], 0x0
    s_add_u32 s74, s74, 2097152
    s_addc_u32 s75, s75, 0
    s_load_dword s79, s[74:75], 0x0
    s_branch L_pt2
L_pt1:
    s_add_u32 s74, s74, 8388608
    s_addc_u32 s75, s75, 0
    s_load_dword s76, s[74:75], 0x0
    s_add_u32 s74, s74, 2097152
    s_addc_u32 s75, s75, 0
    s_load_dword s77, s[74:75], 0x0
    s_add_u32 s74, s74, 2097148
    s_addc_u32 s75, s75, 0
    s_load_dword s78, s[74:75], 0x0
    s_load_dword s79, s[80:81], 0x0
L_pt2:
    s_bitcmp1_b32 s66, 4
    s_cselect_b64 s[74:75], s[40:41], s[38:39]
    s_and_b32 s82, s66, 7
    s_lshl_b32 s82, s82, 21
    s_min_u32 s82, s82, 12582908
    s_xor_b32 s83, s6, 2
    s_add_u32 s83, s83, 20
    s_mul_i32 s83, s83, 12582912
    s_add_u32 s82, s82, s83
    s_add_u32 s74, s74, s82
    s_addc_u32 s75, s75, 0
    s_load_dword s82, s[74:75], 0x0
    v_add_u32 v33, 46592, v4
    v_mov_b32 v34, 46400
    v_add_u32 v35, 0, v7
    v_mov_b32 v38, 0
    s_mov_b32 s12, 0x3d93cd3a
    s_mov_b32 s13, 0x3fb8aa3b
    s_mov_b32 s63, 0
    s_lshl_b32 s68, s6, 17
    s_add_u32 s68, s68, 524288
L_wt:
    s_sleep 2
    ds_read_b32 v10, v38 offset:46528
    s_waitcnt lgkmcnt(0)
    v_cmp_gt_u32 vcc, 256, v10
    s_cbranch_vccnz L_wt
    s_mov_b32 s69, 1048576
    s_add_u32 s67, s68, 0
    buffer_load_dwordx4 v[56:59], v7, s[16:19], s67 offen offset:0
    buffer_load_dwordx4 v[60:63], v7, s[16:19], s67 offen offset:2048
    s_add_u32 s67, s68, 4096
    buffer_load_dwordx4 v[64:67], v7, s[16:19], s67 offen offset:0
    buffer_load_dwordx4 v[68:71], v7, s[16:19], s67 offen offset:2048
    s_add_u32 s67, s68, 8192
    buffer_load_dwordx4 v[72:75], v7, s[16:19], s67 offen offset:0
    buffer_load_dwordx4 v[76:79], v7, s[16:19], s67 offen offset:2048
    s_add_u32 s67, s68, 12288
    buffer_load_dwordx4 v[80:83], v7, s[16:19], s67 offen offset:0
    buffer_load_dwordx4 v[84:87], v7, s[16:19], s67 offen offset:2048
    s_add_u32 s67, s68, 16384
    buffer_load_dwordx4 v[88:91], v7, s[16:19], s67 offen offset:0
    buffer_load_dwordx4 v[92:95], v7, s[16:19], s67 offen offset:2048
    s_add_u32 s67, s68, 20480
    buffer_load_dwordx4 v[96:99], v7, s[16:19], s67 offen offset:0
    buffer_load_dwordx4 v[100:103], v7, s[16:19], s67 offen offset:2048
    s_add_u32 s67, s68, 24576
    buffer_load_dwordx4 v[104:107], v7, s[16:19], s67 offen offset:0
    buffer_load_dwordx4 v[108:111], v7, s[16:19], s67 offen offset:2048
    s_add_u32 s67, s68, 28672
    buffer_load_dwordx4 v[112:115], v7, s[16:19], s67 offen offset:0
    buffer_load_dwordx4 v[116:119], v7, s[16:19], s67 offen offset:2048
    s_branch L_gq_chk
L_gq:
    s_sleep 4
L_gq_go:
    s_add_u32 s67, s68, 0
    buffer_load_dwordx4 v[56:59], v7, s[16:19], s67 offen offset:0 sc1
    buffer_load_dwordx4 v[60:63], v7, s[16:19], s67 offen offset:2048 sc1
    s_add_u32 s67, s68, 4096
    buffer_load_dwordx4 v[64:67], v7, s[16:19], s67 offen offset:0 sc1
    buffer_load_dwordx4 v[68:71], v7, s[16:19], s67 offen offset:2048 sc1
    s_add_u32 s67, s68, 8192
    buffer_load_dwordx4 v[72:75], v7, s[16:19], s67 offen offset:0 sc1
    buffer_load_dwordx4 v[76:79], v7, s[16:19], s67 offen offset:2048 sc1
    s_add_u32 s67, s68, 12288
    buffer_load_dwordx4 v[80:83], v7, s[16:19], s67 offen offset:0 sc1
    buffer_load_dwordx4 v[84:87], v7, s[16:19], s67 offen offset:2048 sc1
    s_add_u32 s67, s68, 16384
    buffer_load_dwordx4 v[88:91], v7, s[16:19], s67 offen offset:0 sc1
    buffer_load_dwordx4 v[92:95], v7, s[16:19], s67 offen offset:2048 sc1
    s_add_u32 s67, s68, 20480
    buffer_load_dwordx4 v[96:99], v7, s[16:19], s67 offen offset:0 sc1
    buffer_load_dwordx4 v[100:103], v7, s[16:19], s67 offen offset:2048 sc1
    s_add_u32 s67, s68, 24576
    buffer_load_dwordx4 v[104:107], v7, s[16:19], s67 offen offset:0 sc1
    buffer_load_dwordx4 v[108:111], v7, s[16:19], s67 offen offset:2048 sc1
    s_add_u32 s67, s68, 28672
    buffer_load_dwordx4 v[112:115], v7, s[16:19], s67 offen offset:0 sc1
    buffer_load_dwordx4 v[116:119], v7, s[16:19], s67 offen offset:2048 sc1
L_gq_chk:
    s_waitcnt vmcnt(0)
    v_xor_b32 v44, s46, v59
    v_bitop3_b32 v44, v63, s46, v44 bitop3:0xbe
    v_bitop3_b32 v44, v67, s46, v44 bitop3:0xbe
    v_bitop3_b32 v44, v71, s46, v44 bitop3:0xbe
    v_bitop3_b32 v44, v75, s46, v44 bitop3:0xbe
    v_bitop3_b32 v44, v79, s46, v44 bitop3:0xbe
    v_bitop3_b32 v44, v83, s46, v44 bitop3:0xbe
    v_bitop3_b32 v44, v87, s46, v44 bitop3:0xbe
    v_bitop3_b32 v44, v91, s46, v44 bitop3:0xbe
    v_bitop3_b32 v44, v95, s46, v44 bitop3:0xbe
    v_bitop3_b32 v44, v99, s46, v44 bitop3:0xbe
    v_bitop3_b32 v44, v103, s46, v44 bitop3:0xbe
    v_bitop3_b32 v44, v107, s46, v44 bitop3:0xbe
    v_bitop3_b32 v44, v111, s46, v44 bitop3:0xbe
    v_bitop3_b32 v44, v115, s46, v44 bitop3:0xbe
    v_bitop3_b32 v44, v119, s46, v44 bitop3:0xbe
    v_cmp_ne_u32 vcc, 0, v44
    s_cbranch_vccz L_gq_done
    s_sub_u32 s69, s69, 1
    s_cbranch_scc0 L_gq
L_gq_done:
    v_add_f32 v56, v56, v60
    v_add_f32 v57, v57, v61
    v_add_f32 v58, v58, v62
    v_add_f32 v88, v88, v92
    v_add_f32 v89, v89, v93
    v_add_f32 v90, v90, v94
    v_add_f32 v56, v56, v64
    v_add_f32 v57, v57, v65
    v_add_f32 v58, v58, v66
    v_add_f32 v88, v88, v96
    v_add_f32 v89, v89, v97
    v_add_f32 v90, v90, v98
    v_add_f32 v56, v56, v68
    v_add_f32 v57, v57, v69
    v_add_f32 v58, v58, v70
    v_add_f32 v88, v88, v100
    v_add_f32 v89, v89, v101
    v_add_f32 v90, v90, v102
    v_add_f32 v56, v56, v72
    v_add_f32 v57, v57, v73
    v_add_f32 v58, v58, v74
    v_add_f32 v88, v88, v104
    v_add_f32 v89, v89, v105
    v_add_f32 v90, v90, v106
    v_add_f32 v56, v56, v76
    v_add_f32 v57, v57, v77
    v_add_f32 v58, v58, v78
    v_add_f32 v88, v88, v108
    v_add_f32 v89, v89, v109
    v_add_f32 v90, v90, v110
    v_add_f32 v56, v56, v80
    v_add_f32 v57, v57, v81
    v_add_f32 v58, v58, v82
    v_add_f32 v88, v88, v112
    v_add_f32 v89, v89, v113
    v_add_f32 v90, v90, v114
    v_add_f32 v56, v56, v84
    v_add_f32 v57, v57, v85
    v_add_f32 v58, v58, v86
    v_add_f32 v88, v88, v116
    v_add_f32 v89, v89, v117
    v_add_f32 v90, v90, v118
    v_cvt_pk_bf16_f32 v56, v56, 0
    v_cvt_pk_bf16_f32 v57, v57, 0
    v_cvt_pk_bf16_f32 v58, v58, 0
    v_cvt_pk_bf16_f32 v88, v88, 0
    v_cvt_pk_bf16_f32 v89, v89, 0
    v_cvt_pk_bf16_f32 v90, v90, 0
    ds_write_b16 v32, v56 offset:42944
    ds_write_b16 v32, v57 offset:43072
    ds_write_b16 v32, v58 offset:43200
    ds_write_b16 v32, v88 offset:43328
    ds_write_b16 v32, v89 offset:43456
    ds_write_b16 v32, v90 offset:43584
    s_branch L_next
L_blk:
    s_cmp_lg_u32 s66, 0
    s_cbranch_scc1 L_noxf
    s_bitcmp1_b32 0x8888888, s63
    s_cbranch_scc0 L_noxf
    s_add_u32 s67, s46, s63
    v_mov_b32 v12, s67
    v_mul_u32_u24 v13, 4224, v0
    s_mul_i32 s68, s65, 4224
    s_add_u32 s68, s68, 458752
    s_mov_b64 exec, 1
    buffer_store_dword v12, v13, s[16:19], s68 offen sc1
    s_mov_b32 s68, 458752
    s_mov_b64 exec, 0xff
    buffer_load_dword v14, v13, s[16:19], s68 offen sc1
    s_waitcnt vmcnt(0)
    v_sub_u32 v14, v14, v12
    v_cmp_gt_u32 vcc, 64, v14
    s_nop 0
    s_bitset0_b32 vcc_lo, s65
    s_bcnt1_i32_b64 s67, vcc
    s_lshl_b32 s67, s67, 2
    s_lshr_b32 s67, 0x23579bde, s67
    s_and_b32 s67, s67, 15
    s_getreg_b32 s68, hwreg(HW_REG_XCC_ID)
    s_bitcmp1_b32 s68, 0
    s_cselect_b32 s68, 18, 14
    s_add_u32 s67, s67, s68
    s_min_u32 s67, s67, 32
    s_add_u32 s67, s67, s46
    v_mov_b32 v12, s67
    s_mul_i32 s68, s65, 16896
    s_add_u32 s68, s68, 262272
    s_mov_b64 exec, 0xf
    buffer_store_dword v12, v13, s[16:19], s68 offen
    s_mov_b64 exec, -1
L_noxf:
    s_cmp_le_u32 s63, 16
    s_cbranch_scc1 L_kpart
    s_bitcmp1_b32 0x55740001, s63
    s_cbranch_scc0 L_vmid
    ds_read_b96 v[56:58], v35 offset:0
    ds_read_b96 v[60:62], v35 offset:1024
    ds_read_b96 v[64:66], v35 offset:2048
    ds_read_b96 v[68:70], v35 offset:3072
    v_xor_b32 v35, 4096, v35
    v_mov_b32 v75, s74
    s_waitcnt lgkmcnt(0)
    v_add_f32 v56, v56, v60
    v_add_f32 v64, v64, v68
    v_add_f32 v57, v57, v61
    v_add_f32 v65, v65, v69
    v_add_f32 v58, v58, v62
    v_add_f32 v66, v66, v70
    v_add_f32 v56, v56, v64
    v_add_f32 v57, v57, v65
    v_add_f32 v58, v58, v66
    v_mul_f32 v72, s20, v56
    v_mul_f32 v73, s20, v57
    v_mul_f32 v74, s20, v58
    s_cmp_eq_u32 s72, 0
    s_cbranch_scc1 L_s1_r
    buffer_store_dwordx4 v[72:75], v17, s[16:19], s75 offen
    s_branch L_s1_d
L_s1_r:
    buffer_store_dwordx4 v[72:75], v17, s[16:19], s75 offen sc1
L_s1_d:
    s_mov_b32 s69, 1048576
L_p1:
    s_cmp_eq_u32 s72, 0
    s_cbranch_scc1 L_p1_rm
    buffer_load_dwordx4 v[56:59], v18, s[16:19], s76 offen nt
    s_branch L_p1_chk
L_p1_rm:
    buffer_load_dwordx4 v[56:59], v18, s[16:19], s76 offen sc1
L_p1_chk:
    s_waitcnt vmcnt(0)
    v_cmp_ne_u32 vcc, s74, v59
    s_cbranch_vccz L_p1_done
    s_sub_u32 s69, s69, 1
    s_cbranch_scc0 L_p1
L_p1_done:
    v_mov_b32 v59, 0
    v_permlane32_swap_b32 v56, v57
    s_nop 0
    v_permlane32_swap_b32 v58, v59
    v_add_f32 v56, v56, v57
    v_add_f32 v58, v58, v59
    s_nop 1
    v_permlane16_swap_b32 v56, v58
    v_add_f32 v40, v56, v58
    s_nop 1
    v_add_f32_dpp v40, v40, v40 quad_perm:[1,0,3,2] row_mask:0xf bank_mask:0xf
    s_nop 1
    v_add_f32_dpp v40, v40, v40 quad_perm:[2,3,0,1] row_mask:0xf bank_mask:0xf
    s_nop 1
    v_add_f32_dpp v40, v40, v40 row_half_mirror row_mask:0xf bank_mask:0xf
    s_cmp_eq_u32 s63, 32
    s_cbranch_scc1 L_tail
    s_mov_b32 s20, s21
    s_mov_b32 s21, s22
    s_mov_b32 s22, s24
    s_mov_b32 s24, s25
    s_mov_b32 s25, s26
    s_mov_b32 s26, s28
    s_mov_b32 s28, s29
    s_mov_b32 s29, s30
    s_add_u32 s74, s74, 1
    s_xor_b32 s75, s75, 1024
    s_xor_b32 s76, s76, 1024
    s_lshr_b32 s67, s6, 1
    s_add_u32 s67, s67, 21
    s_cmp_lg_u32 s67, s63
    s_cbranch_scc1 L_native
    v_mov_b32 v15, v40
    s_branch L_next
L_native:
    s_add_u32 s67, s63, 1
    s_lshr_b32 s67, s67, 1
    s_xor_b32 s67, s67, s71
    s_bitcmp1_b32 s67, 0
    s_cbranch_scc0 L_notmine
    v_mov_b32 v8, v9
    v_mov_b32 v9, v10
    v_mov_b32 v10, v40
    s_cmp_eq_u32 s63, 28
    s_cbranch_scc0 L_next
    s_branch L_send
L_notmine:
    v_mov_b32 v52, v53
    v_mov_b32 v53, v54
    v_mov_b32 v54, v40
    s_cmp_ge_u32 s63, 28
    s_cbranch_scc0 L_next
L_send:
    v_readlane_b32 s67, v15, 0
    s_nop 3
    v_writelane_b32 v52, s67, 48
    v_readlane_b32 s67, v15, 8
    s_nop 3
    v_writelane_b32 v53, s67, 48
    v_readlane_b32 s67, v15, 16
    s_nop 3
    v_writelane_b32 v54, s67, 48
    v_readlane_b32 s67, v15, 24
    s_nop 3
    v_writelane_b32 v52, s67, 56
    v_readlane_b32 s67, v15, 32
    s_nop 3
    v_writelane_b32 v53, s67, 56
    v_readlane_b32 s67, v15, 40
    s_nop 3
    v_writelane_b32 v54, s67, 56
    s_mov_b32 exec_lo, 0x01010101
    s_mov_b32 exec_hi, 0x01010101
    buffer_store_dwordx4 v[52:55], v42, s[16:19], s81 offen sc1
    s_mov_b64 exec, -1
    s_add_u32 s81, s81, 128
    s_branch L_next
L_vmid:
    s_cmp_lg_u32 s63, 17
    s_cbranch_scc1 L_nols
    s_mul_i32 s68, s6, 8192
    s_add_u32 s68, s68, 32768
    s_add_u32 s70, s68, 4096
    s_xor_b32 s67, s68, 16384
    v_lshlrev_b32 v6, 7, v0
    s_mov_b32 s69, 1048576
    buffer_load_dwordx4 v[88:91], v6, s[16:19], s68 offen offset:80
    buffer_load_dwordx4 v[92:95], v6, s[16:19], s67 offen offset:80
    buffer_load_dwordx4 v[56:59], v36, s[16:19], s68 offen offset:0
    buffer_load_dwordx4 v[60:63], v36, s[16:19], s68 offen offset:1024
    buffer_load_dwordx4 v[64:67], v36, s[16:19], s68 offen offset:2048
    buffer_load_dwordx4 v[68:71], v36, s[16:19], s68 offen offset:3072
    buffer_load_dwordx4 v[72:75], v36, s[16:19], s70 offen offset:0
    buffer_load_dwordx4 v[76:79], v36, s[16:19], s70 offen offset:1024
    buffer_load_dwordx4 v[80:83], v36, s[16:19], s70 offen offset:2048
    buffer_load_dwordx4 v[84:87], v36, s[16:19], s70 offen offset:3072
    s_branch L_ls_chk
L_ls:
    s_sleep 16
L_ls_go:
    buffer_load_dwordx4 v[88:91], v6, s[16:19], s68 offen offset:80 sc1
    buffer_load_dwordx4 v[92:95], v6, s[16:19], s67 offen offset:80 sc1
    buffer_load_dwordx4 v[56:59], v36, s[16:19], s68 offen offset:0 sc1
    buffer_load_dwordx4 v[60:63], v36, s[16:19], s68 offen offset:1024 sc1
    buffer_load_dwordx4 v[64:67], v36, s[16:19], s68 offen offset:2048 sc1
    buffer_load_dwordx4 v[68:71], v36, s[16:19], s68 offen offset:3072 sc1
    buffer_load_dwordx4 v[72:75], v36, s[16:19], s70 offen offset:0 sc1
    buffer_load_dwordx4 v[76:79], v36, s[16:19], s70 offen offset:1024 sc1
    buffer_load_dwordx4 v[80:83], v36, s[16:19], s70 offen offset:2048 sc1
    buffer_load_dwordx4 v[84:87], v36, s[16:19], s70 offen offset:3072 sc1
L_ls_chk:
    s_waitcnt vmcnt(0)
    v_xor_b32 v44, s46, v57
    v_bitop3_b32 v44, v59, s46, v44 bitop3:0xbe
    v_bitop3_b32 v44, v61, s46, v44 bitop3:0xbe
    v_bitop3_b32 v44, v63, s46, v44 bitop3:0xbe
    v_bitop3_b32 v44, v65, s46, v44 bitop3:0xbe
    v_bitop3_b32 v44, v67, s46, v44 bitop3:0xbe
    v_bitop3_b32 v44, v69, s46, v44 bitop3:0xbe
    v_bitop3_b32 v44, v71, s46, v44 bitop3:0xbe
    v_bitop3_b32 v44, v73, s46, v44 bitop3:0xbe
    v_bitop3_b32 v44, v75, s46, v44 bitop3:0xbe
    v_bitop3_b32 v44, v77, s46, v44 bitop3:0xbe
    v_bitop3_b32 v44, v79, s46, v44 bitop3:0xbe
    v_bitop3_b32 v44, v81, s46, v44 bitop3:0xbe
    v_bitop3_b32 v44, v83, s46, v44 bitop3:0xbe
    v_bitop3_b32 v44, v85, s46, v44 bitop3:0xbe
    v_bitop3_b32 v44, v87, s46, v44 bitop3:0xbe
    v_bitop3_b32 v44, v89, s46, v44 bitop3:0xbe
    v_bitop3_b32 v44, v91, s46, v44 bitop3:0xbe
    v_bitop3_b32 v44, v93, s46, v44 bitop3:0xbe
    v_bitop3_b32 v44, v95, s46, v44 bitop3:0xbe
    v_cmp_ne_u32 vcc, 0, v44
    s_cbranch_vccz L_ls_done
    s_sub_u32 s69, s69, 1
    s_cbranch_scc0 L_ls
L_ls_done:
    v_xor_b32 v44, s72, v58
    v_bitop3_b32 v44, v62, s72, v44 bitop3:0xbe
    v_bitop3_b32 v44, v66, s72, v44 bitop3:0xbe
    v_bitop3_b32 v44, v70, s72, v44 bitop3:0xbe
    v_xor_b32 v45, s72, v74
    v_bitop3_b32 v45, v78, s72, v45 bitop3:0xbe
    v_bitop3_b32 v45, v82, s72, v45 bitop3:0xbe
    v_bitop3_b32 v45, v86, s72, v45 bitop3:0xbe
    s_bitcmp1_b32 s65, 0
    s_cselect_b64 vcc, -1, 0
    v_cndmask_b32 v44, v44, v45, vcc
    v_cmp_ne_u32 vcc, 0, v44
    s_nop 0
    s_and_b32 vcc_hi, vcc_hi, 0xffff00ff
    s_cmp_eq_u64 vcc, 0
    s_cselect_b32 s72, 1, 0
    v_max_f32 v44, v56, v60
    v_max3_f32 v44, v44, v64, v68
    v_max3_f32 v44, v44, v72, v76
    v_max3_f32 v44, v44, v80, v84
    s_nop 1
    v_max_f32_dpp v44, v44, v44 quad_perm:[1,0,3,2] row_mask:0xf bank_mask:0xf
    s_nop 1
    v_max_f32_dpp v44, v44, v44 quad_perm:[2,3,0,1] row_mask:0xf bank_mask:0xf
    s_nop 1
    v_max_f32_dpp v44, v44, v44 row_half_mirror row_mask:0xf bank_mask:0xf
    v_sub_f32 v56, v56, v44
    v_sub_f32 v60, v60, v44
    v_sub_f32 v64, v64, v44
    v_sub_f32 v68, v68, v44
    v_sub_f32 v72, v72, v44
    v_sub_f32 v76, v76, v44
    v_sub_f32 v80, v80, v44
    v_sub_f32 v84, v84, v44
    v_exp_f32 v56, v56
    v_exp_f32 v60, v60
    v_exp_f32 v64, v64
    v_exp_f32 v68, v68
    v_exp_f32 v72, v72
    v_exp_f32 v76, v76
    v_exp_f32 v80, v80
    v_exp_f32 v84, v84
    v_add_f32 v56, v56, v60
    v_add_f32 v56, v56, v64
    v_add_f32 v56, v56, v68
    v_add_f32 v56, v56, v72
    v_add_f32 v56, v56, v76
    v_add_f32 v56, v56, v80
    v_add_f32 v56, v56, v84
    s_nop 1
    v_add_f32_dpp v56, v56, v56 quad_perm:[1,0,3,2] row_mask:0xf bank_mask:0xf
    s_nop 1
    v_add_f32_dpp v56, v56, v56 quad_perm:[2,3,0,1] row_mask:0xf bank_mask:0xf
    s_nop 1
    v_add_f32_dpp v56, v56, v56 row_half_mirror row_mask:0xf bank_mask:0xf
    v_sub_f32 v44, v37, v44
    v_exp_f32 v44, v44
    v_rcp_f32 v45, v56
    s_nop 0
    v_mul_f32 v44, v44, v45
    s_nop 0
    v_readlane_b32 s20, v44, 48
    v_readlane_b32 s21, v44, 56
    v_readlane_b32 s25, v44, 32
    v_readlane_b32 s26, v44, 24
    v_readlane_b32 s28, v44, 16
    v_readlane_b32 s29, v44, 8
    v_readlane_b32 s30, v44, 0
    v_max_f32 v44, v88, v92
    v_max_f32 v45, v90, v94
    s_nop 0
    v_max_f32_dpp v44, v44, v44 quad_perm:[1,0,3,2] row_mask:0xf bank_mask:0xf
    v_max_f32_dpp v45, v45, v45 quad_perm:[1,0,3,2] row_mask:0xf bank_mask:0xf
    s_nop 0
    v_max_f32_dpp v44, v44, v44 quad_perm:[2,3,0,1] row_mask:0xf bank_mask:0xf
    v_max_f32_dpp v45, v45, v45 quad_perm:[2,3,0,1] row_mask:0xf bank_mask:0xf
    s_nop 0
    v_max_f32_dpp v44, v44, v44 row_half_mirror row_mask:0xf bank_mask:0xf
    v_max_f32_dpp v45, v45, v45 row_half_mirror row_mask:0xf bank_mask:0xf
    s_nop 0
    v_max_f32_dpp v44, v44, v44 row_mirror row_mask:0xf bank_mask:0xf
    v_max_f32_dpp v45, v45, v45 row_mirror row_mask:0xf bank_mask:0xf
    v_mov_b32 v46, v44
    v_mov_b32 v47, v45
    s_nop 0
    v_permlane16_swap_b32 v46, v44
    v_permlane16_swap_b32 v47, v45
    v_max_f32 v44, v44, v46
    v_max_f32 v45, v45, v47
    v_mov_b32 v46, v44
    v_mov_b32 v47, v45
    s_nop 0
    v_permlane32_swap_b32 v46, v44
    v_permlane32_swap_b32 v47, v45
    v_max_f32 v44, v44, v46
    v_max_f32 v45, v45, v47
    v_sub_f32 v88, v88, v44
    v_sub_f32 v92, v92, v44
    v_sub_f32 v90, v90, v45
    v_sub_f32 v94, v94, v45
    v_exp_f32 v88, v88
    v_exp_f32 v92, v92
    v_exp_f32 v90, v90
    v_exp_f32 v94, v94
    v_add_f32 v88, v88, v92
    v_add_f32 v90, v90, v94
    s_nop 0
    v_add_f32_dpp v88, v88, v88 quad_perm:[1,0,3,2] row_mask:0xf bank_mask:0xf
    v_add_f32_dpp v90, v90, v90 quad_perm:[1,0,3,2] row_mask:0xf bank_mask:0xf
    s_nop 0
    v_add_f32_dpp v88, v88, v88 quad_perm:[2,3,0,1] row_mask:0xf bank_mask:0xf
    v_add_f32_dpp v90, v90, v90 quad_perm:[2,3,0,1] row_mask:0xf bank_mask:0xf
    s_nop 0
    v_add_f32_dpp v88, v88, v88 row_half_mirror row_mask:0xf bank_mask:0xf
    v_add_f32_dpp v90, v90, v90 row_half_mirror row_mask:0xf bank_mask:0xf
    s_nop 0
    v_add_f32_dpp v88, v88, v88 row_mirror row_mask:0xf bank_mask:0xf
    v_add_f32_dpp v90, v90, v90 row_mirror row_mask:0xf bank_mask:0xf
    v_mov_b32 v46, v88
    v_mov_b32 v47, v90
    s_nop 0
    v_permlane16_swap_b32 v46, v88
    v_permlane16_swap_b32 v47, v90
    v_add_f32 v88, v88, v46
    v_add_f32 v90, v90, v47
    v_mov_b32 v46, v88
    v_mov_b32 v47, v90
    s_nop 0
    v_permlane32_swap_b32 v46, v88
    v_permlane32_swap_b32 v47, v90
    v_add_f32 v88, v88, v46
    v_add_f32 v90, v90, v47
    v_sub_f32 v44, v37, v44
    v_sub_f32 v45, v30, v45
    v_exp_f32 v44, v44
    v_exp_f32 v45, v45
    v_rcp_f32 v46, v88
    v_rcp_f32 v47, v90
    v_mul_f32 v44, v44, v46
    v_mul_f32 v45, v45, v47
    v_readlane_b32 s24, v44, 40
    v_readlane_b32 s22, v45, 40
    v_mov_b32 v44, 0
    v_mov_b32 v45, 0
    v_mov_b32 v46, 0
    v_mov_b32 v47, s72
    s_mov_b64 exec, 0xf
    ds_write_b128 v7, v[44:47] offset:36416
    s_lshl_b32 s67, s64, 11
    s_add_u32 s67, s67, 524288
    s_mov_b32 exec_lo, 0x3f3f3f3f
    s_mov_b32 exec_hi, 0x3f3f3f3f
    s_cmp_eq_u32 s72, 0
    s_cbranch_scc1 L_s0_r
    buffer_store_dwordx4 v[48:51], v5, s[16:19], s67 offen offset:1024
    s_branch L_s0_d
L_s0_r:
    buffer_store_dwordx4 v[48:51], v5, s[16:19], s67 offen offset:1024 sc1
L_s0_d:
    s_mov_b64 exec, -1
    s_branch L_next
L_nols:
    s_cmp_lg_u32 s63, 19
    s_cbranch_scc1 L_nogu2
    v_lshlrev_b32 v6, 11, v2
    v_lshl_add_u32 v6, v3, 4, v6
    v_mov_b32 v64, 0
    v_mov_b32 v65, 0
    s_lshr_b32 s68, s64, 3
    s_lshl_b32 s68, s68, 14
    s_mul_i32 s67, s5, 96
    s_add_u32 s68, s68, s67
    s_add_u32 s68, s68, 524288
    s_mov_b32 exec_lo, 0x3f3f3f3f
    s_mov_b32 exec_hi, 0x3f3f3f3f
    s_mov_b32 s69, 1048576
    s_branch L_gu_go
L_gu:
    s_sleep 4
L_gu_go:
    s_cmp_eq_u32 s72, 0
    s_cbranch_scc1 L_gu_rm
    buffer_load_dwordx4 v[64:67], v6, s[16:19], s68 offen offset:1024 nt
    s_branch L_gu_chk
L_gu_rm:
    buffer_load_dwordx4 v[64:67], v6, s[16:19], s68 offen offset:1024 sc1
L_gu_chk:
    s_waitcnt vmcnt(0)
    v_xor_b32 v44, s46, v66
    v_bitop3_b32 v44, v67, s46, v44 bitop3:0xbe
    v_cmp_ne_u32 vcc, 0, v44
    s_cbranch_vccz L_gu_done
    s_sub_u32 s69, s69, 1
    s_cbranch_scc0 L_gu
L_gu_done:
    s_mov_b64 exec, -1
    v_add_f32_dpp v64, v64, v64 row_ror:8 row_mask:0xf bank_mask:0xf
    v_add_f32_dpp v65, v65, v65 row_ror:8 row_mask:0xf bank_mask:0xf
    v_mov_b32 v44, v64
    v_mov_b32 v45, v65
    s_nop 0
    v_permlane16_swap_b32 v44, v64
    v_permlane16_swap_b32 v45, v65
    v_add_f32 v64, v64, v44
    v_add_f32 v65, v65, v45
    v_mov_b32 v44, v64
    v_mov_b32 v45, v65
    s_nop 0
    v_permlane32_swap_b32 v44, v64
    v_permlane32_swap_b32 v45, v65
    v_add_f32 v64, v64, v44
    v_add_f32 v65, v65, v45
    v_cvt_pk_bf16_f32 v64, 0, v64
    v_cvt_pk_bf16_f32 v65, 0, v65
    v_cmp_lt_f32 vcc, 0, v64
    s_nop 1
    v_cndmask_b32 v44, 0, 1.0, vcc
    v_mul_f32 v47, v64, v44
    v_mul_f32 v47, v47, v65
    v_cvt_pk_bf16_f32 v47, v47, 0
    s_nop 1
    v_mov_b32_dpp v44, v47 quad_perm:[1,1,3,3] row_mask:0xf bank_mask:0xf
    v_lshl_or_b32 v47, v44, 16, v47
    s_nop 0
    v_readlane_b32 s60, v47, 0
    v_readlane_b32 s61, v47, 2
    v_readlane_b32 s62, v47, 4
    ds_read_b32 v104, v16 offset:0
    ds_read_b32 v105, v16 offset:4
    ds_read_b32 v106, v16 offset:8
    ds_read_b32 v107, v16 offset:12
    ds_read_b32 v108, v16 offset:16
    ds_read_b32 v109, v16 offset:1280
    ds_read_b32 v110, v16 offset:1284
    ds_read_b32 v111, v16 offset:1288
    ds_read_b32 v112, v16 offset:1292
    ds_read_b32 v113, v16 offset:1296
    s_waitcnt lgkmcnt(0)
    ds_read_b32 v114, v16 offset:2560
    ds_read_b32 v115, v16 offset:2564
    ds_read_b32 v116, v16 offset:2568
    ds_read_b32 v117, v16 offset:2572
    ds_read_b32 v118, v16 offset:2576
    ds_read_b32 v119, v16 offset:3840
    ds_read_b32 v120, v16 offset:3844
    ds_read_b32 v121, v16 offset:3848
    ds_read_b32 v122, v16 offset:3852
    ds_read_b32 v123, v16 offset:3856
    s_waitcnt lgkmcnt(0)
    ds_read_b32 v124, v16 offset:5120
    ds_read_b32 v125, v16 offset:5124
    ds_read_b32 v126, v16 offset:5128
    ds_read_b32 v127, v16 offset:5132
    ds_read_b32 v128, v16 offset:5136
    ds_read_b32 v129, v16 offset:6400
    ds_read_b32 v130, v16 offset:6404
    ds_read_b32 v131, v16 offset:6408
    ds_read_b32 v132, v16 offset:6412
    ds_read_b32 v133, v16 offset:6416
    s_waitcnt lgkmcnt(0)
    s_mov_b32 s68, 0x05040100
    s_mov_b32 s70, 0x07060302
    v_perm_b32 v136, v109, v104, s68
    v_perm_b32 v137, v109, v104, s70
    v_perm_b32 v138, v110, v105, s68
    v_perm_b32 v139, v110, v105, s70
    v_perm_b32 v140, v111, v106, s68
    v_perm_b32 v141, v111, v106, s70
    v_perm_b32 v142, v112, v107, s68
    v_perm_b32 v143, v112, v107, s70
    v_perm_b32 v144, v113, v108, s68
    v_perm_b32 v145, v113, v108, s70
    v_perm_b32 v146, v119, v114, s68
    v_perm_b32 v147, v119, v114, s70
    v_perm_b32 v148, v120, v115, s68
    v_perm_b32 v149, v120, v115, s70
    v_perm_b32 v150, v121, v116, s68
    v_perm_b32 v151, v121, v116, s70
    v_perm_b32 v152, v122, v117, s68
    v_perm_b32 v153, v122, v117, s70
    v_perm_b32 v154, v123, v118, s68
    v_perm_b32 v155, v123, v118, s70
    v_perm_b32 v156, v129, v124, s68
    v_perm_b32 v157, v129, v124, s70
    v_perm_b32 v158, v130, v125, s68
    v_perm_b32 v159, v130, v125, s70
    v_perm_b32 v160, v131, v126, s68
    v_perm_b32 v161, v131, v126, s70
    v_perm_b32 v162, v132, v127, s68
    v_perm_b32 v163, v132, v127, s70
    v_perm_b32 v164, v133, v128, s68
    v_perm_b32 v165, v133, v128, s70
    v_dot2c_f32_bf16 v168, s60, v136
    v_dot2c_f32_bf16 v169, s60, v137
    v_dot2c_f32_bf16 v170, s60, v138
    v_dot2c_f32_bf16 v171, s60, v139
    v_dot2c_f32_bf16 v172, s60, v140
    v_dot2c_f32_bf16 v173, s60, v141
    v_dot2c_f32_bf16 v174, s60, v142
    v_dot2c_f32_bf16 v175, s60, v143
    v_dot2c_f32_bf16 v176, s60, v144
    v_dot2c_f32_bf16 v177, s60, v145
    v_dot2c_f32_bf16 v168, s61, v146
    v_dot2c_f32_bf16 v169, s61, v147
    v_dot2c_f32_bf16 v170, s61, v148
    v_dot2c_f32_bf16 v171, s61, v149
    v_dot2c_f32_bf16 v172, s61, v150
    v_dot2c_f32_bf16 v173, s61, v151
    v_dot2c_f32_bf16 v174, s61, v152
    v_dot2c_f32_bf16 v175, s61, v153
    v_dot2c_f32_bf16 v176, s61, v154
    v_dot2c_f32_bf16 v177, s61, v155
    v_dot2c_f32_bf16 v168, s62, v156
    v_dot2c_f32_bf16 v169, s62, v157
    v_dot2c_f32_bf16 v170, s62, v158
    v_dot2c_f32_bf16 v171, s62, v159
    v_dot2c_f32_bf16 v172, s62, v160
    v_dot2c_f32_bf16 v173, s62, v161
    v_dot2c_f32_bf16 v174, s62, v162
    v_dot2c_f32_bf16 v175, s62, v163
    v_dot2c_f32_bf16 v176, s62, v164
    v_dot2c_f32_bf16 v177, s62, v165
    ds_write_b64 v21, v[168:169] offset:33792
    ds_write_b64 v21, v[170:171] offset:33800
    ds_write_b64 v21, v[172:173] offset:33808
    ds_write_b64 v21, v[174:175] offset:33816
    ds_write_b64 v21, v[176:177] offset:33824
    s_branch L_next
L_nogu2:
    s_cmp_lg_u32 s63, 31
    s_cbranch_scc1 L_nopf
L_nopf:
    s_cmp_lt_u32 s63, 29
    s_cbranch_scc1 L_next
    s_add_u32 s67, s63, s71
    s_cmp_gt_u32 s67, 31
    s_cbranch_scc1 L_last
    s_mov_b32 s69, 1048576
    s_branch L_px_go
L_px:
    s_sleep 4
L_px_go:
    buffer_load_dwordx4 v[56:59], v42, s[16:19], s82 offen sc1
L_px_chk:
    s_waitcnt vmcnt(0)
    v_cmp_ne_u32 vcc, s46, v59
    s_cbranch_vccz L_px_done
    s_sub_u32 s69, s69, 1
    s_cbranch_scc0 L_px
L_px_done:
    v_add_f32 v8, v8, v56
    v_add_f32 v9, v9, v57
    v_add_f32 v10, v10, v58
    s_add_u32 s67, s63, s71
    s_cmp_lg_u32 s67, 29
    s_cbranch_scc1 L_nofo
    s_xor_b32 s68, s82, 32768
    s_xor_b32 s70, s82, 40960
    s_mov_b32 s69, 1048576
    s_branch L_pf_go
L_pf:
    s_sleep 4
L_pf_go:
    buffer_load_dwordx4 v[56:59], v31, s[16:19], s68 offen sc1
    buffer_load_dwordx4 v[60:63], v31, s[16:19], s70 offen sc1
L_pf_chk:
    s_waitcnt vmcnt(0)
    v_xor_b32 v44, s46, v59
    v_bitop3_b32 v44, v63, s46, v44 bitop3:0xbe
    v_cmp_ne_u32 vcc, 0, v44
    s_cbranch_vccz L_pf_done
    s_sub_u32 s69, s69, 1
    s_cbranch_scc0 L_pf
L_pf_done:
    v_add_f32 v56, v56, v60
    v_add_f32 v57, v57, v61
    v_add_f32 v58, v58, v62
    s_mov_b32 vcc_lo, 0x0000ff00
    s_mov_b32 vcc_hi, 0x000000ff
    v_cndmask_b32 v56, v56, v57, vcc
    s_mov_b32 vcc_lo, 0x00ff0000
    s_mov_b32 vcc_hi, 0x0000ff00
    v_cndmask_b32 v56, v56, v58, vcc
    v_add_f32 v9, v9, v56
L_nofo:
    s_add_u32 s82, s82, 128
    s_mov_b32 s83, 3
    s_cmp_eq_u32 s63, 29
    s_cbranch_scc1 L_take
    s_mov_b32 s83, 1
    v_mov_b32 v8, v10
L_take:
    s_nop 1
    v_mov_b32_dpp v57, v8 row_ror:8 row_mask:0xf bank_mask:0xf
    v_cvt_pk_bf16_f32 v56, v8, v57
    v_mov_b32 v8, v9
    v_mov_b32 v9, v10
    s_mov_b32 exec_lo, 0x00010001
    s_mov_b32 exec_hi, 1
    ds_write_b32 v29, v56
    s_mov_b64 exec, -1
    v_add_u32 v29, 16, v29
    s_sub_u32 s83, s83, 1
    s_cmp_gt_u32 s83, 0
    s_cbranch_scc1 L_take
L_last:
    s_cmp_lg_u32 s63, 31
    s_cbranch_scc1 L_next
    s_setprio 3
    s_waitcnt vmcnt(0)
L_next:
    s_add_u32 s63, s63, 1
    s_waitcnt lgkmcnt(0)
    s_barrier
    s_branch L_blk
L_kpart:
    s_setprio 0
    s_and_b32 s67, s63, 1
    s_cbranch_scc1 L_nosm
    ds_read_b32 v56, v33 offset:0
    ds_read_b32 v57, v33 offset:256
    ds_read_b32 v58, v33 offset:4096
    ds_read_b32 v59, v33 offset:4352
    s_waitcnt lgkmcnt(0)
    ds_read_b32 v60, v33 offset:8192
    ds_read_b32 v61, v33 offset:8448
    ds_read_b32 v62, v33 offset:12288
    ds_read_b32 v63, v33 offset:12544
    s_waitcnt lgkmcnt(0)
    v_cvt_pk_bf16_f32 v56, 0, v56
    v_cvt_pk_bf16_f32 v57, 0, v57
    v_cvt_pk_bf16_f32 v58, 0, v58
    v_cvt_pk_bf16_f32 v59, 0, v59
    v_cvt_pk_bf16_f32 v60, 0, v60
    v_cvt_pk_bf16_f32 v61, 0, v61
    v_cvt_pk_bf16_f32 v62, 0, v62
    v_cvt_pk_bf16_f32 v63, 0, v63
    v_mul_f32 v56, s12, v56
    v_mul_f32 v57, s12, v57
    v_mul_f32 v58, s12, v58
    v_mul_f32 v59, s12, v59
    v_mul_f32 v60, s12, v60
    v_mul_f32 v61, s12, v61
    v_mul_f32 v62, s12, v62
    v_mul_f32 v63, s12, v63
    v_cvt_pk_bf16_f32 v56, 0, v56
    v_cvt_pk_bf16_f32 v57, 0, v57
    v_cvt_pk_bf16_f32 v58, 0, v58
    v_cvt_pk_bf16_f32 v59, 0, v59
    v_cvt_pk_bf16_f32 v60, 0, v60
    v_cvt_pk_bf16_f32 v61, 0, v61
    v_cvt_pk_bf16_f32 v62, 0, v62
    v_cvt_pk_bf16_f32 v63, 0, v63
    v_mul_f32 v56, s13, v56
    v_mul_f32 v57, s13, v57
    v_mul_f32 v58, s13, v58
    v_mul_f32 v59, s13, v59
    v_mul_f32 v60, s13, v60
    v_mul_f32 v61, s13, v61
    v_mul_f32 v62, s13, v62
    v_mul_f32 v63, s13, v63
    v_max_f32 v64, v56, v58
    v_max3_f32 v64, v64, v60, v62
    v_max_f32 v66, v57, v59
    v_max3_f32 v66, v66, v61, v63
    v_max_f32_dpp v64, v64, v64 quad_perm:[1,0,3,2] row_mask:0xf bank_mask:0xf
    s_nop 0
    v_max_f32_dpp v66, v66, v66 quad_perm:[1,0,3,2] row_mask:0xf bank_mask:0xf
    v_max_f32_dpp v64, v64, v64 quad_perm:[2,3,0,1] row_mask:0xf bank_mask:0xf
    s_nop 0
    v_max_f32_dpp v66, v66, v66 quad_perm:[2,3,0,1] row_mask:0xf bank_mask:0xf
    v_max_f32_dpp v64, v64, v64 row_half_mirror row_mask:0xf bank_mask:0xf
    s_nop 0
    v_max_f32_dpp v66, v66, v66 row_half_mirror row_mask:0xf bank_mask:0xf
    v_max_f32_dpp v64, v64, v64 row_mirror row_mask:0xf bank_mask:0xf
    s_nop 0
    v_max_f32_dpp v66, v66, v66 row_mirror row_mask:0xf bank_mask:0xf
    v_mov_b32 v44, v64
    v_mov_b32 v45, v66
    s_nop 0
    v_permlane16_swap_b32 v44, v64
    v_permlane16_swap_b32 v45, v66
    v_max_f32 v64, v64, v44
    v_max_f32 v66, v66, v45
    v_mov_b32 v44, v64
    v_mov_b32 v45, v66
    s_nop 0
    v_permlane32_swap_b32 v44, v64
    v_permlane32_swap_b32 v45, v66
    v_max_f32 v64, v64, v44
    v_max_f32 v66, v66, v45
    s_cmp_eq_u32 s63, 12
    s_cbranch_scc1 L_sm1
    v_max_f32 v64, v64, v66
    v_mov_b32 v66, v64
    s_branch L_sm0
L_sm1:
    v_mov_b32_dpp v56, v56 row_half_mirror row_mask:0xf bank_mask:0xf
    v_mov_b32_dpp v58, v58 row_half_mirror row_mask:0xf bank_mask:0xf
    v_mov_b32_dpp v60, v60 row_half_mirror row_mask:0xf bank_mask:0xf
    v_mov_b32_dpp v62, v62 row_half_mirror row_mask:0xf bank_mask:0xf
L_sm0:
    v_sub_f32 v56, v56, v64
    v_sub_f32 v57, v57, v66
    v_sub_f32 v58, v58, v64
    v_sub_f32 v59, v59, v66
    v_sub_f32 v60, v60, v64
    v_sub_f32 v61, v61, v66
    v_sub_f32 v62, v62, v64
    v_sub_f32 v63, v63, v66
    v_exp_f32 v56, v56
    v_exp_f32 v57, v57
    v_exp_f32 v58, v58
    v_exp_f32 v59, v59
    v_exp_f32 v60, v60
    v_exp_f32 v61, v61
    v_exp_f32 v62, v62
    v_exp_f32 v63, v63
    v_add_f32 v65, v56, v58
    v_add_f32 v65, v65, v60
    v_add_f32 v65, v65, v62
    v_add_f32 v67, v57, v59
    v_add_f32 v67, v67, v61
    v_add_f32 v67, v67, v63
    v_cvt_pk_bf16_f32 v56, v56, 0
    v_cvt_pk_bf16_f32 v57, v57, 0
    v_cvt_pk_bf16_f32 v58, v58, 0
    v_cvt_pk_bf16_f32 v59, v59, 0
    v_cvt_pk_bf16_f32 v60, v60, 0
    v_cvt_pk_bf16_f32 v61, v61, 0
    v_cvt_pk_bf16_f32 v62, v62, 0
    v_cvt_pk_bf16_f32 v63, v63, 0
    ds_write_b32 v33, v56 offset:0
    ds_write_b32 v33, v57 offset:256
    ds_write_b32 v33, v58 offset:4096
    ds_write_b32 v33, v59 offset:4352
    ds_write_b32 v33, v60 offset:8192
    ds_write_b32 v33, v61 offset:8448
    ds_write_b32 v33, v62 offset:12288
    ds_write_b32 v33, v63 offset:12544
    v_add_f32_dpp v65, v65, v65 quad_perm:[1,0,3,2] row_mask:0xf bank_mask:0xf
    v_add_f32_dpp v67, v67, v67 quad_perm:[1,0,3,2] row_mask:0xf bank_mask:0xf
    s_nop 0
    v_add_f32_dpp v65, v65, v65 quad_perm:[2,3,0,1] row_mask:0xf bank_mask:0xf
    v_add_f32_dpp v67, v67, v67 quad_perm:[2,3,0,1] row_mask:0xf bank_mask:0xf
    s_nop 0
    v_add_f32_dpp v65, v65, v65 row_half_mirror row_mask:0xf bank_mask:0xf
    v_add_f32_dpp v67, v67, v67 row_half_mirror row_mask:0xf bank_mask:0xf
    s_nop 0
    v_add_f32_dpp v65, v65, v65 row_mirror row_mask:0xf bank_mask:0xf
    v_add_f32_dpp v67, v67, v67 row_mirror row_mask:0xf bank_mask:0xf
    v_mov_b32 v44, v65
    v_mov_b32 v45, v67
    s_nop 0
    v_permlane16_swap_b32 v44, v65
    v_permlane16_swap_b32 v45, v67
    v_add_f32 v65, v65, v44
    v_add_f32 v67, v67, v45
    v_mov_b32 v44, v65
    v_mov_b32 v45, v67
    s_nop 0
    v_permlane32_swap_b32 v44, v65
    v_permlane32_swap_b32 v45, v67
    v_add_f32 v65, v65, v44
    v_add_f32 v67, v67, v45
    s_cmp_eq_u32 s63, 12
    s_cbranch_scc1 L_sm2
    v_add_f32 v65, v65, v67
    s_branch L_sm3
L_sm2:
    v_log_f32 v67, v67
    s_nop 0
    v_add_f32 v67, v67, v66
    ds_write_b64 v38, v[66:67] offset:46464
L_sm3:
    v_log_f32 v65, v65
    s_nop 0
    v_add_f32 v65, v65, v64
    ds_write_b64 v34, v[64:65]
    v_add_u32 v33, 512, v33
    v_add_u32 v34, 8, v34
L_nosm:
    s_cmp_lg_u32 s63, 1
    s_cbranch_scc1 L_noq1
    s_cmp_lg_u32 s5, 0
    s_cbranch_scc1 L_next
    s_cmp_lt_u32 s7, 16
    s_cbranch_scc1 L_next
    s_mov_b32 s69, 1048576
    s_add_u32 s67, s73, 0
    buffer_load_dwordx4 v[56:59], v7, s[16:19], s67 offen offset:0 sc1
    buffer_load_dwordx4 v[60:63], v7, s[16:19], s67 offen offset:2048 sc1
    s_add_u32 s67, s73, 4096
    buffer_load_dwordx4 v[64:67], v7, s[16:19], s67 offen offset:0 sc1
    buffer_load_dwordx4 v[68:71], v7, s[16:19], s67 offen offset:2048 sc1
    s_add_u32 s67, s73, 8192
    buffer_load_dwordx4 v[72:75], v7, s[16:19], s67 offen offset:0 sc1
    buffer_load_dwordx4 v[76:79], v7, s[16:19], s67 offen offset:2048 sc1
    s_add_u32 s67, s73, 12288
    buffer_load_dwordx4 v[80:83], v7, s[16:19], s67 offen offset:0 sc1
    buffer_load_dwordx4 v[84:87], v7, s[16:19], s67 offen offset:2048 sc1
    s_branch L_go_chk
L_go:
    s_sleep 4
L_go_go:
    s_add_u32 s67, s73, 0
    buffer_load_dwordx4 v[56:59], v7, s[16:19], s67 offen offset:0 sc1
    buffer_load_dwordx4 v[60:63], v7, s[16:19], s67 offen offset:2048 sc1
    s_add_u32 s67, s73, 4096
    buffer_load_dwordx4 v[64:67], v7, s[16:19], s67 offen offset:0 sc1
    buffer_load_dwordx4 v[68:71], v7, s[16:19], s67 offen offset:2048 sc1
    s_add_u32 s67, s73, 8192
    buffer_load_dwordx4 v[72:75], v7, s[16:19], s67 offen offset:0 sc1
    buffer_load_dwordx4 v[76:79], v7, s[16:19], s67 offen offset:2048 sc1
    s_add_u32 s67, s73, 12288
    buffer_load_dwordx4 v[80:83], v7, s[16:19], s67 offen offset:0 sc1
    buffer_load_dwordx4 v[84:87], v7, s[16:19], s67 offen offset:2048 sc1
L_go_chk:
    s_waitcnt vmcnt(0)
    v_xor_b32 v44, s46, v59
    v_bitop3_b32 v44, v63, s46, v44 bitop3:0xbe
    v_bitop3_b32 v44, v67, s46, v44 bitop3:0xbe
    v_bitop3_b32 v44, v71, s46, v44 bitop3:0xbe
    v_bitop3_b32 v44, v75, s46, v44 bitop3:0xbe
    v_bitop3_b32 v44, v79, s46, v44 bitop3:0xbe
    v_bitop3_b32 v44, v83, s46, v44 bitop3:0xbe
    v_bitop3_b32 v44, v87, s46, v44 bitop3:0xbe
    v_cmp_ne_u32 vcc, 0, v44
    s_cbranch_vccz L_go_done
    s_sub_u32 s69, s69, 1
    s_cbranch_scc0 L_go
L_go_done:
    v_add_f32 v56, v56, v60
    v_add_f32 v57, v57, v61
    v_add_f32 v58, v58, v62
    v_add_f32 v56, v56, v64
    v_add_f32 v57, v57, v65
    v_add_f32 v58, v58, v66
    v_add_f32 v56, v56, v68
    v_add_f32 v57, v57, v69
    v_add_f32 v58, v58, v70
    v_add_f32 v56, v56, v72
    v_add_f32 v57, v57, v73
    v_add_f32 v58, v58, v74
    v_add_f32 v56, v56, v76
    v_add_f32 v57, v57, v77
    v_add_f32 v58, v58, v78
    v_add_f32 v56, v56, v80
    v_add_f32 v57, v57, v81
    v_add_f32 v58, v58, v82
    v_add_f32 v56, v56, v84
    v_add_f32 v57, v57, v85
    v_add_f32 v58, v58, v86
    v_mov_b32_dpp v60, v56 row_ror:8 row_mask:0xf bank_mask:0xf
    v_mov_b32_dpp v61, v57 row_ror:8 row_mask:0xf bank_mask:0xf
    v_mov_b32_dpp v62, v58 row_ror:8 row_mask:0xf bank_mask:0xf
    v_cvt_pk_bf16_f32 v56, v56, v60
    v_cvt_pk_bf16_f32 v57, v57, v61
    v_cvt_pk_bf16_f32 v58, v58, v62
    v_lshrrev_b32 v6, 4, v0
    v_lshl_add_u32 v6, v6, 3, v3
    v_lshlrev_b32 v6, 4, v6
    s_lshl_b32 s67, s64, 6
    s_add_u32 s67, s67, 16384
    s_mov_b32 exec_lo, 0x00ff00ff
    s_mov_b32 exec_hi, 0x00ff00ff
    buffer_store_dwordx4 v[56:59], v6, s[16:19], s67 offen sc1
    s_mov_b64 exec, -1
    s_waitcnt vmcnt(0)
    s_branch L_next
L_noq1:
    s_cmp_lg_u32 s63, 2
    s_cbranch_scc1 L_noq2
    s_lshl_b32 s68, s6, 12
    s_add_u32 s68, s68, 16384
    s_xor_b32 s70, s68, 8192
    v_lshrrev_b32 v32, 5, v0
    v_mul_u32_u24 v32, 384, v32
    v_lshl_add_u32 v32, v3, 4, v32
    v_and_b32 v6, 3, v2
    v_lshl_add_u32 v32, v6, 2, v32
    s_waitcnt lgkmcnt(0)
    v_mov_b32 v59, s46
    s_mov_b32 s69, 1048576
    s_mov_b32 exec_hi, 0
    buffer_load_dwordx4 v[56:59], v7, s[16:19], s70 offen offset:2560
    s_mov_b32 exec_hi, -1
    buffer_load_dwordx4 v[60:63], v7, s[16:19], s68 offen offset:1024
    buffer_load_dwordx4 v[64:67], v7, s[16:19], s68 offen offset:2048
    buffer_load_dwordx4 v[68:71], v7, s[16:19], s68 offen offset:3072
    s_branch L_gf_chk
L_gf:
    s_cmp_lg_u32 s69, 1048568
    s_cbranch_scc1 L_nore
    buffer_store_dwordx4 v[52:55], v7, s[16:19], s73 offen sc1
L_nore:
    s_sleep 4
L_gf_go:
    s_mov_b32 exec_hi, 0
    buffer_load_dwordx4 v[56:59], v7, s[16:19], s70 offen offset:2560 sc1
    s_mov_b32 exec_hi, -1
    buffer_load_dwordx4 v[60:63], v7, s[16:19], s68 offen offset:1024 sc1
    buffer_load_dwordx4 v[64:67], v7, s[16:19], s68 offen offset:2048 sc1
    buffer_load_dwordx4 v[68:71], v7, s[16:19], s68 offen offset:3072 sc1
L_gf_chk:
    s_waitcnt vmcnt(0)
    v_xor_b32 v44, s46, v59
    v_bitop3_b32 v44, v63, s46, v44 bitop3:0xbe
    v_bitop3_b32 v44, v67, s46, v44 bitop3:0xbe
    v_bitop3_b32 v44, v71, s46, v44 bitop3:0xbe
    v_cmp_ne_u32 vcc, 0, v44
    s_cbranch_vccz L_gf_done
    s_sub_u32 s69, s69, 1
    s_cbranch_scc0 L_gf
L_gf_done:
    ds_write_b32 v32, v60 offset:43712
    ds_write_b32 v32, v61 offset:43840
    ds_write_b32 v32, v62 offset:43968
    ds_write_b32 v32, v64 offset:44480
    ds_write_b32 v32, v65 offset:44608
    ds_write_b32 v32, v66 offset:44736
    ds_write_b32 v32, v68 offset:45248
    ds_write_b32 v32, v69 offset:45376
    ds_write_b32 v32, v70 offset:45504
    s_mov_b32 exec_hi, 0
    ds_write_b32 v32, v56 offset:46016
    ds_write_b32 v32, v57 offset:46144
    ds_write_b32 v32, v58 offset:46272
    s_mov_b32 exec_hi, -1
    s_branch L_next
L_noq2:
    s_cmp_lg_u32 s63, 9
    s_cbranch_scc1 L_nogu
    v_mul_u32_u24 v16, 20, v0
    v_add_u32 v16, 8192, v16
    v_lshrrev_b32 v44, 4, v0
    v_lshl_add_u32 v44, v44, 3, v3
    v_and_b32 v45, 8, v0
    v_lshlrev_b32 v45, 1, v45
    v_lshl_add_u32 v17, v44, 5, v45
    v_lshl_add_u32 v18, v44, 11, v45
    s_lshl_b32 s75, s64, 11
    s_add_u32 s75, s75, 1048576
    s_lshl_b32 s76, s65, 16
    s_lshl_b32 s67, s66, 5
    s_add_u32 s76, s76, s67
    s_add_u32 s76, s76, 1048576
    v_mul_u32_u24 v21, 40, v0
    v_lshrrev_b32 v29, 1, v0
    v_and_b32 v29, 8, v29
    v_lshrrev_b32 v44, 3, v0
    v_and_or_b32 v29, v44, 4, v29
    v_add_u32 v29, 36416, v29
    v_mov_b32 v43, v29
    v_lshlrev_b32 v44, 4, v3
    v_lshl_add_u32 v19, v2, 11, v44
    v_lshlrev_b32 v42, 4, v2
    v_mov_b32 v41, s46
    v_mov_b32 v55, s46
    v_mov_b32 v31, 96
    v_mov_b32 v45, 112
    v_cmp_lt_u32 vcc, 2, v2
    s_nop 1
    v_cndmask_b32 v31, v31, v45, vcc
    s_add_u32 s77, s46, 32
    s_lshr_b32 s68, s66, 3
    s_mov_b32 s78, 2621440
    s_cmp_eq_u32 s68, 0
    s_cselect_b32 s78, 1049600, s78
    s_cmp_eq_u32 s68, 1
    s_cselect_b32 s78, 525312, s78
    s_cmp_eq_u32 s68, 2
    s_cselect_b32 s78, 524288, s78
    s_lshl_b32 s67, s65, 16
    s_add_u32 s78, s78, s67
    s_lshl_b32 s67, s5, 7
    s_add_u32 s78, s78, s67
    s_lshl_b32 s80, s66, 10
    s_add_u32 s80, s80, 65536
    s_lshl_b32 s67, s65, 7
    s_add_u32 s79, s80, s67
    s_lshl_b32 s81, s64, 8
    s_add_u32 s81, s81, 131072
    s_xor_b32 s82, s81, 8192
    s_add_u32 s74, s46, 1
    s_mov_b32 s83, 0
    v_mul_u32_u24 v44, 3, v3
    s_mul_i32 s67, s66, 20
    v_add_lshl_u32 v44, v44, s67, 1
    v_mov_b32 v46, 1073741824
    v_cmp_gt_u32 vcc, 7, v3
    s_nop 1
    v_cndmask_b32 v22, v46, v44, vcc
    v_cmp_gt_u32 vcc, 6, v3
    s_nop 1
    v_cndmask_b32 v23, v46, v44, vcc
    v_mov_b32 v44, 0
    v_or_b32 v45, s2, v0
    v_cmp_eq_u32 vcc, 0, v45
    s_nop 1
    v_cndmask_b32 v24, v46, v44, vcc
    buffer_load_ushort v26, v22, s[32:35], 0 offen
    buffer_load_ushort v27, v22, s[32:35], 0 offen offset:2
    buffer_load_ushort v28, v23, s[32:35], 0 offen offset:4
    v_mov_b32 v168, 0
    v_mov_b32 v169, 0
    v_mov_b32 v170, 0
    v_mov_b32 v171, 0
    v_mov_b32 v172, 0
    v_mov_b32 v173, 0
    v_mov_b32 v174, 0
    v_mov_b32 v175, 0
    v_mov_b32 v176, 0
    v_mov_b32 v177, 0
    s_waitcnt vmcnt(0)
    v_lshlrev_b32 v26, 16, v26
    v_lshlrev_b32 v27, 16, v27
    v_lshlrev_b32 v28, 16, v28
    s_mov_b64 s[32:33], s[54:55]
    s_branch L_next
L_nogu:
    s_cmp_lg_u32 s63, 16
    s_cbranch_scc1 L_next
    v_lshrrev_b32 v10, 3, v0
    v_lshlrev_b32 v10, 3, v10
    s_waitcnt lgkmcnt(0)
    ds_read_b64 v[46:47], v10 offset:46400
    ds_read_b64 v[56:57], v38 offset:46464
    s_lshl_b32 s68, s64, 7
    s_add_u32 s68, s68, 32768
    v_and_b32 v11, 7, v0
    v_cmp_eq_u32 vcc, 0, v11
    s_waitcnt lgkmcnt(0)
    v_mov_b32 v37, v46
    v_mov_b32 v44, v47
    v_mov_b32 v45, s46
    v_mov_b32 v47, s46
    s_getreg_b32 s72, hwreg(HW_REG_XCC_ID)
    v_mov_b32 v46, s72
    v_lshlrev_b32 v10, 1, v10
    v_mov_b32 v30, v56
    v_readlane_b32 s67, v57, 0
    s_nop 3
    v_writelane_b32 v46, s67, 40
    s_mov_b64 exec, vcc
    buffer_store_dwordx4 v[44:47], v10, s[16:19], s68 offen sc1
    s_mov_b64 exec, -1
    v_lshl_add_u32 v36, v11, 7, v10
    s_branch L_next
L_tail:
    v_mov_b32_dpp v57, v40 row_ror:8 row_mask:0xf bank_mask:0xf
    v_cvt_pk_bf16_f32 v56, v40, v57
    s_mov_b32 exec_lo, 0x00010001
    s_mov_b32 exec_hi, 1
    ds_write_b32 v43, v56 offset:64
    s_mov_b64 exec, -1
    s_waitcnt lgkmcnt(0)
    s_barrier
    s_mov_b32 s69, 1048576
L_p2:
    s_cmp_eq_u32 s72, 0
    s_cbranch_scc1 L_p2_rm
    s_add_u32 s67, s78, 0
    buffer_load_dwordx4 v[56:59], v19, s[16:19], s67 offen nt
    s_add_u32 s67, s78, 16384
    buffer_load_dwordx4 v[60:63], v19, s[16:19], s67 offen nt
    s_add_u32 s67, s78, 32768
    buffer_load_dwordx4 v[64:67], v19, s[16:19], s67 offen nt
    s_add_u32 s67, s78, 49152
    buffer_load_dwordx4 v[68:71], v19, s[16:19], s67 offen nt
    s_branch L_p2_chk
L_p2_rm:
    s_add_u32 s67, s78, 0
    buffer_load_dwordx4 v[56:59], v19, s[16:19], s67 offen sc1
    s_add_u32 s67, s78, 16384
    buffer_load_dwordx4 v[60:63], v19, s[16:19], s67 offen sc1
    s_add_u32 s67, s78, 32768
    buffer_load_dwordx4 v[64:67], v19, s[16:19], s67 offen sc1
    s_add_u32 s67, s78, 49152
    buffer_load_dwordx4 v[68:71], v19, s[16:19], s67 offen sc1
L_p2_chk:
    s_waitcnt vmcnt(0)
    v_xor_b32 v44, s77, v59
    v_bitop3_b32 v44, v63, s77, v44 bitop3:0xbe
    v_bitop3_b32 v44, v67, s77, v44 bitop3:0xbe
    v_bitop3_b32 v44, v71, s77, v44 bitop3:0xbe
    v_cmp_ne_u32 vcc, 0, v44
    s_cbranch_vccz L_p2_done
    s_sub_u32 s69, s69, 1
    s_cbranch_scc0 L_p2
L_p2_done:
    v_add_f32 v56, v56, v60
    v_add_f32 v64, v64, v68
    v_add_f32 v57, v57, v61
    v_add_f32 v65, v65, v69
    v_add_f32 v58, v58, v62
    v_add_f32 v66, v66, v70
    v_add_f32 v56, v56, v64
    v_add_f32 v57, v57, v65
    v_add_f32 v58, v58, v66
    v_add_f32_dpp v56, v56, v56 row_ror:8 row_mask:0xf bank_mask:0xf
    v_add_f32_dpp v57, v57, v57 row_ror:8 row_mask:0xf bank_mask:0xf
    v_add_f32_dpp v58, v58, v58 row_ror:8 row_mask:0xf bank_mask:0xf
    v_mov_b32 v60, v56
    v_mov_b32 v61, v57
    v_mov_b32 v62, v58
    v_permlane16_swap_b32 v60, v56
    v_permlane16_swap_b32 v61, v57
    v_permlane16_swap_b32 v62, v58
    v_add_f32 v56, v56, v60
    v_add_f32 v57, v57, v61
    v_add_f32 v58, v58, v62
    v_mov_b32 v60, v56
    v_mov_b32 v61, v57
    v_mov_b32 v62, v58
    v_permlane32_swap_b32 v60, v56
    v_permlane32_swap_b32 v61, v57
    v_permlane32_swap_b32 v62, v58
    v_add_f32 v56, v56, v60
    v_add_f32 v57, v57, v61
    v_add_f32 v58, v58, v62
    s_cmp_eq_u32 s5, s65
    s_cbranch_scc1 L_red
    s_mov_b64 exec, 0xff
    buffer_store_dwordx4 v[56:59], v7, s[16:19], s79 offen sc1
    s_mov_b64 exec, -1
    s_branch L_done
L_red:
    v_mov_b32 v72, v56
    v_mov_b32 v73, v57
    v_mov_b32 v74, v58
    v_cmp_ne_u32 vcc, s65, v2
    s_mov_b32 s69, 1048576
    s_mov_b64 exec, vcc
L_p3:
    buffer_load_dwordx4 v[72:75], v7, s[16:19], s80 offen sc1
    s_waitcnt vmcnt(0)
    v_cmp_ne_u32 vcc, s77, v75
    s_cbranch_vccz L_p3d0
    s_sub_u32 s69, s69, 1
    s_cbranch_scc0 L_p3
L_p3d0:
    s_mov_b64 exec, -1
    v_add_f32_dpp v64, v72, v72 row_ror:8 row_mask:0xf bank_mask:0xf
    v_add_f32_dpp v65, v73, v73 row_ror:8 row_mask:0xf bank_mask:0xf
    v_add_f32_dpp v66, v74, v74 row_ror:8 row_mask:0xf bank_mask:0xf
L_p3e:
    v_mov_b32 v68, v64
    v_mov_b32 v69, v65
    v_mov_b32 v70, v66
    v_permlane16_swap_b32 v68, v64
    v_permlane16_swap_b32 v69, v65
    v_permlane16_swap_b32 v70, v66
    v_add_f32 v64, v64, v68
    v_add_f32 v65, v65, v69
    v_add_f32 v66, v66, v70
    v_mov_b32 v68, v64
    v_mov_b32 v69, v65
    v_mov_b32 v70, v66
    v_permlane32_swap_b32 v68, v64
    v_permlane32_swap_b32 v69, v65
    v_permlane32_swap_b32 v70, v66
    v_add_f32 v64, v64, v68
    v_add_f32 v65, v65, v69
    v_add_f32 v66, v66, v70
    v_add_f32 v64, v64, v26
    v_add_f32 v65, v65, v27
    v_add_f32 v66, v66, v28
    v_cvt_pk_bf16_f32 v64, v64, 0
    v_cvt_pk_bf16_f32 v65, v65, 0
    v_cvt_pk_bf16_f32 v66, v66, 0
    s_mov_b64 exec, 0xff
    buffer_store_short v64, v22, s[32:35], 0 offen
    buffer_store_short v65, v22, s[32:35], 0 offen offset:2
    buffer_store_short v66, v23, s[32:35], 0 offen offset:4
    buffer_store_dword v41, v24, s[16:19], 0 offen
    s_mov_b64 exec, -1
L_done:
L_end:
    s_endpgm
.section .rodata,"a"
.p2align 6
.amdhsa_kernel parallel_sum__mha_block_cached__glu_gated_reglu__decode_kernel
.amdhsa_next_free_vgpr 200
.amdhsa_next_free_sgpr 102
.amdhsa_accum_offset 200
.amdhsa_group_segment_fixed_size 0
.amdhsa_kernarg_size 96
.amdhsa_user_sgpr_count 2
.amdhsa_user_sgpr_kernarg_segment_ptr 1
.amdhsa_system_sgpr_workgroup_id_x 1
.amdhsa_float_denorm_mode_32 3
.end_amdhsa_kernel
```
